```python
import torch

def _softmax(x, axis=-1):
    return torch.softmax(x, dim=axis)
def _gelu(x):
    return torch.nn.functional.gelu(x, approximate="tanh")
def _silu(x):
    return torch.nn.functional.silu(x)
def _sigmoid(x):
    return torch.sigmoid(x)
def _layernorm(x, axis=-1, eps=1e-5):
    m = x.mean(dim=axis, keepdim=True)
    v = x.var(dim=axis, keepdim=True, unbiased=False)
    return (x - m) / torch.sqrt(v + eps)
def _scatter_add(tgt, idx, src, axis=0):
    return tgt.clone().index_add_(axis, idx, src)
def _segment_sum(src, seg, n):
    out = torch.zeros((n,) + src.shape[1:], dtype=src.dtype)
    return out.index_add_(0, seg, src)
def _pad(x, pw):
    flat = tuple(v for pair in reversed(pw) for v in pair)
    return torch.nn.functional.pad(x, flat)

kernel_name = 'interleave_layers__mha_block_cached__glu_gated_swiglu__decode'

def setup_inputs():

    _w = (lambda a: (lambda t: t.to(torch.bfloat16) if t.is_floating_point() else t)(torch.as_tensor(a)))
    def _A_setup():
        B, Sq, D = 1, 1, 448
        H, Sk, Dh = 16, 32768, 256
        return {
            "x": _w((lambda *s: torch.randn(*s, dtype=torch.bfloat16) * 0.05)(B, Sq, D)),
            "k_cache": _w((lambda *s: torch.randn(*s, dtype=torch.bfloat16) * 1.6)(B, H, Sk, Dh)),
            "v_cache": _w((lambda *s: torch.randn(*s, dtype=torch.bfloat16) * 0.8)(B, H, Sk, Dh)),
            "wq": _w((lambda *s: torch.randn(*s, dtype=torch.bfloat16) * 1.6)(D, H * Dh) * (D ** -0.5)),
            "wo": _w((lambda *s: torch.randn(*s, dtype=torch.bfloat16) * 0.8)(H * Dh, D) * ((H * Dh) ** -0.5)),
        }
    _A_in = _A_setup()

    def _B_setup():
        B, S, D, F = 1, 1, 448, 1792
        return {
            "x": _w((lambda *s: torch.randn(*s, dtype=torch.bfloat16) * 0.05)(B, S, D)),
            "w1": _w((lambda *s: torch.randn(*s, dtype=torch.bfloat16) * 0.4)(D, F) * (2.0 / D) ** 0.5),
            "w3": _w((lambda *s: torch.randn(*s, dtype=torch.bfloat16) * 0.4)(D, F) * (2.0 / D) ** 0.5),
            "w2": _w((lambda *s: torch.randn(*s, dtype=torch.bfloat16) * 0.4)(F, D) * (2.0 / F) ** 0.5),
        }
    _B_in = _B_setup()

    return {
        "A_x": _A_in["x"],
        "A_k_cache": _A_in["k_cache"],
        "A_v_cache": _A_in["v_cache"],
        "A_wq": _A_in["wq"],
        "A_wo": _A_in["wo"],
        "B_x": _B_in["x"],
        "B_w1": _B_in["w1"],
        "B_w3": _B_in["w3"],
        "B_w2": _B_in["w2"],
    }

def reference(A_x, A_k_cache, A_v_cache, A_wq, A_wo, B_x, B_w1, B_w3, B_w2):
    def _A_ref(x, k_cache, v_cache, wq, wo):
        B, Sq, D = x.shape
        H, Dh = 16, 256
        q = (lambda x, *d: x.permute(*d))((x @ wq).reshape(B, Sq, H, Dh), 0, 2, 1, 3)
        scores = torch.einsum("bhqd,bhkd->bhqk", q, k_cache) * (Dh ** -0.5)
        p = _softmax(scores, axis=-1)
        o = torch.einsum("bhqk,bhkd->bhqd", p, v_cache)
        return (lambda x, *d: x.permute(*d))(o, 0, 2, 1, 3).reshape(B, Sq, H * Dh) @ wo

    def _B_ref(x, w1, w3, w2):
        gate = torch.einsum("bsd,df->bsf", x, w1)
        up = torch.einsum("bsd,df->bsf", x, w3)
        h = _silu(gate) * up
        out = torch.einsum("bsf,fd->bsd", h, w2)
        return out

    x = A_x
    x = x + _A_ref(_layernorm(x, axis=-1), A_k_cache, A_v_cache, A_wq, A_wo)
    x = x + _B_ref(_layernorm(x, axis=-1), B_w1, B_w3, B_w2)
    x = x + _A_ref(_layernorm(x, axis=-1), A_k_cache, A_v_cache, A_wq, A_wo)
    x = x + _B_ref(_layernorm(x, axis=-1), B_w1, B_w3, B_w2)
    return x
```

```asm
; @launch grid=(256,1,1) block=(256,1,1) lds=163840
.amdgcn_target "amdgcn-amd-amdhsa--gfx950"
.text
.globl interleave_layers__mha_block_cached__glu_gated_swiglu__decode_kernel
.p2align 8
.type interleave_layers__mha_block_cached__glu_gated_swiglu__decode_kernel,@function
interleave_layers__mha_block_cached__glu_gated_swiglu__decode_kernel:
    s_cmp_ge_u32 s2, 256
    s_cbranch_scc1 L_end
    s_load_dwordx16 s[8:23], s[0:1], 0
    s_load_dwordx8 s[24:31], s[0:1], 64
    v_lshrrev_b32 v1, 6, v0
    v_and_b32 v0, 63, v0
    s_nop 0
    v_readfirstlane_b32 s3, v1
    v_mov_b32 v9, 0
    s_nop 0
    v_readfirstlane_b32 s81, v9
    s_and_b32 s70, s2, 7
    s_lshr_b32 s71, s2, 3
    s_mov_b32 s48, 0
    s_mov_b32 s49, 0
    s_lshr_b32 s72, s70, 1
    s_bitcmp1_b32 s70, 0
    s_cbranch_scc1 L_rodd
    s_and_b32 s49, s71, 15
    s_lshl_b32 s49, s49, 2
    s_add_u32 s49, s49, s72
    s_cmp_lt_u32 s71, 16
    s_cselect_b32 s48, 1, 4
    s_branch L_rdone
L_rodd:
    s_cmp_lt_u32 s71, 14
    s_cbranch_scc0 L_rodd2
    s_mov_b32 s48, 2
    s_mul_i32 s49, s72, 14
    s_add_u32 s49, s49, s71
    s_branch L_rdone
L_rodd2:
    s_cmp_lt_u32 s71, 22
    s_cbranch_scc0 L_rdone
    s_sub_u32 s73, s71, 14
    s_lshr_b32 s74, s73, 2
    s_lshl_b32 s74, s74, 2
    s_add_u32 s74, s74, s72
    s_cmp_lt_u32 s74, 7
    s_cbranch_scc0 L_rdone
    s_mov_b32 s48, 3
    s_and_b32 s73, s73, 3
    s_lshl_b32 s49, s74, 2
    s_add_u32 s49, s49, s73
L_rdone:
    s_add_u32 s48, s48, s81
    s_lshr_b32 s50, s2, 4
    s_and_b32 s51, s2, 15
    s_mov_b32 s70, 65536
    s_mov_b32 s52, 6
    s_cmp_eq_u32 s48, 0
    s_cselect_b32 s70, 7168, s70
    s_cselect_b32 s52, 8, s52
    s_lshl_b32 s71, s52, 12
    s_mul_i32 s72, s71, s3
    s_add_u32 s41, s70, s72
    s_add_u32 s42, s41, s71
    s_mov_b32 s40, s41
    s_mov_b32 s46, s41
    s_lshl_b32 s72, s3, 10
    s_add_u32 s53, s72, 3072
    s_mov_b32 s56, 0x00010001
    s_mov_b32 s57, 0x00010001
    s_lshl_b64 s[58:59], s[56:57], 1
    s_lshl_b64 s[60:61], s[56:57], 2
    s_lshl_b64 s[62:63], s[56:57], 3
    s_mov_b32 s47, s81
    s_waitcnt lgkmcnt(0)
    s_lshl_b32 s70, s50, 4
    s_add_u32 s70, s70, s51
    s_lshl_b32 s70, s70, 20
    s_and_b32 s71, s3, 1
    s_lshl_b32 s71, s71, 12
    s_add_u32 s70, s70, s71
    s_mov_b32 s99, 0
    s_lshr_b32 s93, s2, 3
    s_and_b32 s71, s3, 1
    s_add_u32 s93, s93, s71
    s_add_u32 s32, s10, s70
    s_addc_u32 s33, s11, 0
    s_sub_u32 s32, s32, 3072
    s_subb_u32 s33, s33, 0
    s_and_b32 s33, s33, 0xffff
    s_add_u32 s34, s12, s70
    s_addc_u32 s35, s13, 0
    s_sub_u32 s34, s34, 3072
    s_subb_u32 s35, s35, 0
    s_and_b32 s35, s35, 0xffff
    s_mov_b32 s36, s34
    s_mov_b32 s37, s35
    s_mov_b32 s38, 1047552
    s_mov_b32 s39, 0x20000
    s_mul_i32 s101, s2, 3
    s_and_b32 s101, s101, 63
    s_mul_i32 s101, s101, 16384
    s_mov_b32 s43, s101
    s_mov_b32 s44, 28
    s_mov_b32 s45, 0
    v_bfe_u32 v1, v0, 1, 3
    v_lshlrev_b32 v1, 9, v1
    v_lshrrev_b32 v2, 4, v0
    v_lshl_add_u32 v1, v2, 5, v1
    v_and_b32 v2, 1, v0
    v_lshl_add_u32 v1, v2, 4, v1
    v_add_u32 v1, 3072, v1
    v_subrev_u32 v2, 896, v1
    v_subrev_u32 v3, 1792, v1
    v_subrev_u32 v4, 2688, v1
    s_lshr_b32 s71, s3, 1
    s_lshl_b32 s71, s71, 13
    s_mov_b32 m0, s40
    s_add_u32 s40, s40, 4096
    s_add_u32 s70, s101, 0
    s_and_b32 s70, s70, 0xfffff
    s_add_u32 s70, s70, s71
    buffer_load_dwordx4 v1, s[36:39], s70 offen offset:0 nt lds
    buffer_load_dwordx4 v2, s[36:39], s70 offen offset:1024 nt lds
    buffer_load_dwordx4 v3, s[36:39], s70 offen offset:2048 nt lds
    buffer_load_dwordx4 v4, s[36:39], s70 offen offset:3072 nt lds
    s_mov_b32 m0, s40
    s_add_u32 s40, s40, 4096
    s_add_u32 s70, s101, 16384
    s_and_b32 s70, s70, 0xfffff
    s_add_u32 s70, s70, s71
    buffer_load_dwordx4 v1, s[36:39], s70 offen offset:0 nt lds
    buffer_load_dwordx4 v2, s[36:39], s70 offen offset:1024 nt lds
    buffer_load_dwordx4 v3, s[36:39], s70 offen offset:2048 nt lds
    buffer_load_dwordx4 v4, s[36:39], s70 offen offset:3072 nt lds
    s_add_u32 s93, s93, 2
    s_and_b32 s93, s93, 1
    v_mov_b32 v26, 3072
    global_load_dword v27, v26, s[32:33] nt
    s_mov_b32 s87, 0x20000
    s_mov_b64 s[82:83], -1
    s_mov_b32 s84, s14
    s_and_b32 s85, s15, 0xffff
    s_mov_b32 s86, 0
    s_mov_b32 s94, s53
    s_mov_b32 s95, 0
    s_mov_b32 s96, 0
    s_mov_b32 s97, 0
    s_mov_b32 s98, 0
    s_mov_b32 s7, 99
    s_mov_b32 s6, 0
    s_mov_b64 s[4:5], 0
    v_mov_b32 v12, 0
    s_cmp_eq_u32 s48, 0
    s_cbranch_scc1 L_wdone_start
    s_cmp_eq_u32 s48, 2
    s_cbranch_scc1 L_wdone_start
    s_cmp_eq_u32 s48, 3
    s_cbranch_scc1 L_wdone_start
    s_mov_b32 s95, 1024
    s_cmp_eq_u32 s48, 1
    s_cbranch_scc1 L_wO_start
    s_cmp_eq_u32 s48, 2
    s_cbranch_scc1 L_wB_start
    s_cmp_eq_u32 s48, 3
    s_cbranch_scc1 L_wC_start
    s_mov_b32 s86, 3670016
    v_lshrrev_b32 v9, 3, v0
    v_lshlrev_b32 v12, 13, v9
    v_bfe_u32 v9, v0, 4, 2
    v_lshlrev_b32 v9, 1, v9
    v_and_b32 v10, 7, v0
    v_xor_b32 v9, v9, v10
    v_lshl_add_u32 v12, v9, 4, v12
    s_mul_i32 s71, s3, 917504
    s_lshl_b32 s72, s49, 7
    s_add_u32 s96, s71, s72
    s_mov_b32 s98, 65536
    s_mul_i32 s94, s3, 14336
    s_add_u32 s94, s94, 7168
    s_branch L_wdone_start
L_wC_start:
    s_mov_b32 s84, s24
    s_and_b32 s85, s25, 0xffff
    s_mov_b32 s86, 1605632
    v_lshrrev_b32 v9, 1, v0
    v_mul_u32_u24 v12, 896, v9
    v_and_b32 v9, 1, v0
    v_lshl_add_u32 v12, v9, 4, v12
    s_mul_i32 s71, s3, 401408
    s_lshl_b32 s72, s49, 5
    s_add_u32 s96, s71, s72
    s_mov_b32 s98, 28672
    s_mul_i32 s94, s3, 14336
    s_add_u32 s94, s94, 7168
    s_mov_b32 s97, s96
    s_mov_b32 s6, s94
    s_and_b32 s70, s49, 3
    s_mul_i32 s70, s70, 7
    s_add_u32 s70, s70, 1
    s_lshr_b32 s70, s70, 1
    s_sub_u32 s7, 14, s70
    s_mul_i32 s71, s70, 28672
    s_add_u32 s96, s96, s71
    s_lshl_b32 s71, s70, 10
    s_add_u32 s94, s94, s71
    s_branch L_wdone_start
L_wO_start:
    s_mov_b32 s84, s16
    s_and_b32 s85, s17, 0xffff
    s_mov_b32 s86, 3670016
    v_lshlrev_b32 v12, 4, v0
    s_lshl_b32 s71, s49, 6
    s_lshl_b32 s72, s3, 4
    s_add_u32 s71, s71, s72
    s_mul_i32 s96, s71, 896
    s_mov_b32 s98, 896
    s_mov_b32 s95, 912
    s_mul_i32 s94, s3, 14592
    s_add_u32 s94, s94, 7168
    s_mov_b32 s82, -1
    s_mov_b32 s83, 0x00ffffff
    s_branch L_wdone_start
L_wB_start:
    s_bitcmp1_b32 s49, 0
    s_cselect_b32 s84, s22, s20
    s_cselect_b32 s85, s23, s21
    s_cselect_b32 s4, s20, s22
    s_cselect_b32 s5, s21, s23
    s_cselect_b32 s73, 28704, 0
    s_cselect_b32 s74, 0, 28704
    s_and_b32 s85, s85, 0xffff
    s_and_b32 s5, s5, 0xffff
    s_mov_b32 s86, 1605632
    v_lshrrev_b32 v9, 2, v0
    v_mul_u32_u24 v12, 3584, v9
    v_and_b32 v9, 3, v0
    v_lshl_add_u32 v12, v9, 4, v12
    s_mul_i32 s71, s3, 401408
    s_lshl_b32 s72, s49, 6
    s_add_u32 s96, s71, s72
    s_mov_b32 s97, s96
    s_mov_b32 s98, 57344
    s_mul_i32 s94, s3, 7168
    s_add_u32 s94, s94, 7168
    s_add_u32 s6, s94, s74
    s_add_u32 s94, s94, s73
L_wdone_start:
    s_lshr_b32 s17, s3, 1
    s_lshl_b32 s17, s17, 13
    s_add_u32 s43, s81, 2
    s_add_u32 s44, s81, 28
    s_add_u32 s16, s81, 1
    s_mov_b32 s14, s81
    s_sub_u32 s54, s81, 8
    s_mov_b32 s45, s81
    s_mov_b32 s99, s81
    s_add_u32 s40, s40, s81
    v_min_u32 v9, 55, v0
    v_lshlrev_b32 v9, 4, v9
    global_load_dwordx4 v[16:19], v9, s[8:9]
    s_mov_b32 m0, s94
    s_add_u32 s94, s94, s95
    s_mov_b64 exec, s[82:83]
    buffer_load_dwordx4 v12, s[84:87], s96 offen lds
    s_mov_b64 exec, -1
    s_add_u32 s96, s96, s98
    s_cmp_eq_u32 s7, 1
    s_cselect_b32 s96, s97, s96
    s_cselect_b32 s94, s6, s94
    s_mov_b32 m0, s94
    s_add_u32 s94, s94, s95
    s_mov_b64 exec, s[82:83]
    buffer_load_dwordx4 v12, s[84:87], s96 offen lds
    s_mov_b64 exec, -1
    s_add_u32 s96, s96, s98
    v_mov_b32 v11, 0
    v_lshlrev_b32 v8, 2, v0
    v_add_u32 v8, 2176, v8
    ds_write_b32 v8, v11
    ds_write_b32 v8, v11 offset:256
    s_cmp_eq_u32 s3, 1
    s_cbranch_scc0 Lcp_1
    s_getpc_b64 s[18:19]
L_pcref0:
    s_add_u32 s18, s18, L_p1a_code-L_pcref0
    s_addc_u32 s19, s19, 0
    v_lshlrev_b32 v8, 7, v0
    v_min_u32 v9, L_endcode-L_p1a_code-4, v8
    global_load_dword v24, v9, s[18:19]
    v_add_u32 v8, 8192, v8
    v_min_u32 v9, L_endcode-L_p1a_code-4, v8
    global_load_dword v24, v9, s[18:19]
    v_add_u32 v8, 8192, v8
    v_min_u32 v9, L_endcode-L_p1a_code-4, v8
    global_load_dword v24, v9, s[18:19]
    v_add_u32 v8, 8192, v8
    v_min_u32 v9, L_endcode-L_p1a_code-4, v8
    global_load_dword v24, v9, s[18:19]
    v_add_u32 v8, 8192, v8
Lcp_1:
L_p1a_code:
    v_lshrrev_b32 v5, 5, v0
    v_lshlrev_b32 v5, 12, v5
    v_and_b32 v6, 31, v0
    v_lshl_add_u32 v5, v6, 3, v5
    s_waitcnt vmcnt(5)
    s_call_b64 s[66:67], L_issue
    s_cmp_eq_u32 s7, 2
    s_cselect_b32 s96, s97, s96
    s_cselect_b32 s94, s6, s94
    s_mov_b32 m0, s94
    s_add_u32 s94, s94, s95
    s_mov_b64 exec, s[82:83]
    buffer_load_dwordx4 v12, s[84:87], s96 offen lds
    s_mov_b64 exec, -1
    s_add_u32 s96, s96, s98
    v_mov_b32 v20, -1
    v_mov_b32 v21, -1
    v_mov_b32 v22, -1
    v_mov_b32 v23, -1
    s_lshl_b32 s70, s50, 2
    s_add_u32 s70, s70, s3
    s_lshl_b32 s70, s70, 4
    s_add_u32 s70, s70, s51
    s_mul_i32 s70, s70, 384
    v_min_u32 v25, 16, v0
    v_lshlrev_b32 v25, 4, v25
    v_add_u32 v25, s70, v25
    global_store_dwordx4 v25, v[20:23], s[30:31] sc1
    s_waitcnt vmcnt(6)
    s_call_b64 s[66:67], L_issue
    s_cmp_eq_u32 s7, 3
    s_cselect_b32 s96, s97, s96
    s_cselect_b32 s94, s6, s94
    s_mov_b32 m0, s94
    s_add_u32 s94, s94, s95
    s_mov_b64 exec, s[82:83]
    buffer_load_dwordx4 v12, s[84:87], s96 offen lds
    s_mov_b64 exec, -1
    s_add_u32 s96, s96, s98
    s_lshl_b32 s70, s50, 2
    s_add_u32 s70, s70, s3
    s_lshl_b32 s70, s70, 4
    s_add_u32 s70, s70, s51
    s_mul_i32 s70, s70, 384
    s_add_u32 s70, s70, 0x60000
    v_min_u32 v25, 16, v0
    v_lshlrev_b32 v25, 4, v25
    v_add_u32 v25, s70, v25
    global_store_dwordx4 v25, v[20:23], s[30:31] sc1
    v_add_u32 v6, s46, v5
    ds_read_b64_tr_b16 v[64:65], v6 offset:0
    ds_read_b64_tr_b16 v[68:69], v6 offset:256
    ds_read_b64_tr_b16 v[72:73], v6 offset:512
    ds_read_b64_tr_b16 v[76:77], v6 offset:768
    ds_read_b64_tr_b16 v[80:81], v6 offset:1024
    ds_read_b64_tr_b16 v[84:85], v6 offset:1280
    ds_read_b64_tr_b16 v[88:89], v6 offset:1536
    ds_read_b64_tr_b16 v[92:93], v6 offset:1792
    ds_read_b64_tr_b16 v[96:97], v6 offset:2048
    ds_read_b64_tr_b16 v[100:101], v6 offset:2304
    ds_read_b64_tr_b16 v[104:105], v6 offset:2560
    ds_read_b64_tr_b16 v[108:109], v6 offset:2816
    ds_read_b64_tr_b16 v[112:113], v6 offset:3072
    ds_read_b64_tr_b16 v[116:117], v6 offset:3328
    ds_read_b64_tr_b16 v[120:121], v6 offset:3584
    ds_read_b64_tr_b16 v[124:125], v6 offset:3840
    s_add_u32 s46, s46, 8192
    s_cmp_eq_u32 s46, s42
    s_cselect_b32 s46, s41, s46
    s_waitcnt lgkmcnt(0)
    s_waitcnt vmcnt(6)
    s_call_b64 s[66:67], L_issue
    s_cmp_eq_u32 s7, 4
    s_cselect_b32 s96, s97, s96
    s_cselect_b32 s94, s6, s94
    s_mov_b32 m0, s94
    s_add_u32 s94, s94, s95
    s_mov_b64 exec, s[82:83]
    buffer_load_dwordx4 v12, s[84:87], s96 offen lds
    s_mov_b64 exec, -1
    s_add_u32 s96, s96, s98
    s_lshl_b32 s70, s2, 12
    s_lshl_b32 s71, s3, 10
    s_add_u32 s70, s70, s71
    s_add_u32 s70, s70, 0x300000
    v_mov_b32 v25, v0
    v_lshlrev_b32 v25, 4, v25
    v_add_u32 v25, s70, v25
    global_store_dwordx4 v25, v[20:23], s[30:31] sc1
    s_waitcnt vmcnt(6)
    s_call_b64 s[66:67], L_issue
    s_cmp_eq_u32 s7, 5
    s_cselect_b32 s96, s97, s96
    s_cselect_b32 s94, s6, s94
    s_mov_b32 m0, s94
    s_add_u32 s94, s94, s95
    s_mov_b64 exec, s[82:83]
    buffer_load_dwordx4 v12, s[84:87], s96 offen lds
    s_mov_b64 exec, -1
    s_add_u32 s96, s96, s98
    s_lshl_b32 s70, s2, 12
    s_lshl_b32 s71, s3, 10
    s_add_u32 s70, s70, s71
    s_add_u32 s70, s70, 0x300000
    s_lshl_b32 s72, s49, 7
    s_and_b32 s73, s3, 1
    s_lshr_b32 s74, s3, 1
    s_mul_i32 s71, s74, 0x20000
    s_lshl_b32 s75, s49, 11
    s_add_u32 s71, s71, s75
    s_lshl_b32 s75, s73, 10
    s_add_u32 s71, s71, s75
    s_add_u32 s71, s71, 0x100000
    s_cmp_eq_u32 s48, 1
    s_cselect_b32 s70, s71, s70
    s_lshl_b32 s71, s73, 13
    s_add_u32 s71, s71, s72
    s_add_u32 s75, s71, 0xc8000
    s_cmp_eq_u32 s48, 2
    s_cselect_b32 s70, s75, s70
    s_add_u32 s75, s72, 0xcc000
    s_cmp_eq_u32 s48, 3
    s_cselect_b32 s70, s75, s70
    s_mul_i32 s75, s74, 0xa000
    s_add_u32 s75, s75, s71
    s_add_u32 s75, s75, 0xc4000
    s_cmp_eq_u32 s48, 4
    s_cselect_b32 s70, s75, s70
    v_and_b32 v25, 7, v0
    s_cmp_lt_u32 s48, 2
    s_cselect_b64 vcc, -1, 0
    v_cndmask_b32 v25, v25, v0, vcc
    v_lshlrev_b32 v25, 4, v25
    v_add_u32 v25, s70, v25
    global_store_dwordx4 v25, v[20:23], s[30:31] sc1
    v_add_u32 v6, s46, v5
    ds_read_b64_tr_b16 v[66:67], v6 offset:0
    ds_read_b64_tr_b16 v[70:71], v6 offset:256
    ds_read_b64_tr_b16 v[74:75], v6 offset:512
    ds_read_b64_tr_b16 v[78:79], v6 offset:768
    ds_read_b64_tr_b16 v[82:83], v6 offset:1024
    ds_read_b64_tr_b16 v[86:87], v6 offset:1280
    ds_read_b64_tr_b16 v[90:91], v6 offset:1536
    ds_read_b64_tr_b16 v[94:95], v6 offset:1792
    ds_read_b64_tr_b16 v[98:99], v6 offset:2048
    ds_read_b64_tr_b16 v[102:103], v6 offset:2304
    ds_read_b64_tr_b16 v[106:107], v6 offset:2560
    ds_read_b64_tr_b16 v[110:111], v6 offset:2816
    ds_read_b64_tr_b16 v[114:115], v6 offset:3072
    ds_read_b64_tr_b16 v[118:119], v6 offset:3328
    ds_read_b64_tr_b16 v[122:123], v6 offset:3584
    ds_read_b64_tr_b16 v[126:127], v6 offset:3840
    s_add_u32 s46, s46, 8192
    s_cmp_eq_u32 s46, s42
    s_cselect_b32 s46, s41, s46
    s_waitcnt lgkmcnt(0)
    s_waitcnt vmcnt(6)
    s_call_b64 s[66:67], L_issue
    s_cmp_eq_u32 s7, 6
    s_cselect_b32 s96, s97, s96
    s_cselect_b32 s94, s6, s94
    s_mov_b32 m0, s94
    s_add_u32 s94, s94, s95
    s_mov_b64 exec, s[82:83]
    buffer_load_dwordx4 v12, s[84:87], s96 offen lds
    s_mov_b64 exec, -1
    s_add_u32 s96, s96, s98
    s_lshl_b32 s70, s2, 12
    s_lshl_b32 s71, s3, 10
    s_add_u32 s70, s70, s71
    s_add_u32 s70, s70, 0x300000
    s_lshl_b32 s71, s2, 7
    s_add_u32 s71, s71, 0xd2000
    s_cmp_lt_u32 s2, 16
    s_cselect_b32 s70, s71, s70
    v_and_b32 v25, 7, v0
    v_lshlrev_b32 v25, 4, v25
    v_add_u32 v25, s70, v25
    global_store_dwordx4 v25, v[20:23], s[30:31] sc1
    s_waitcnt vmcnt(6)
    s_call_b64 s[66:67], L_issue
    s_cmp_eq_u32 s48, 2
    s_cselect_b32 s84, s4, s84
    s_cselect_b32 s85, s5, s85
    s_cselect_b32 s96, s97, s96
    s_cselect_b32 s94, s6, s94
    s_cmp_eq_u32 s7, 7
    s_cselect_b32 s96, s97, s96
    s_cselect_b32 s94, s6, s94
    s_mov_b32 m0, s94
    s_add_u32 s94, s94, s95
    s_mov_b64 exec, s[82:83]
    buffer_load_dwordx4 v12, s[84:87], s96 offen lds
    s_mov_b64 exec, -1
    s_add_u32 s96, s96, s98
    v_add_u32 v6, s46, v5
    ds_read_b64_tr_b16 v[128:129], v6 offset:0
    ds_read_b64_tr_b16 v[132:133], v6 offset:256
    ds_read_b64_tr_b16 v[136:137], v6 offset:512
    ds_read_b64_tr_b16 v[140:141], v6 offset:768
    ds_read_b64_tr_b16 v[144:145], v6 offset:1024
    ds_read_b64_tr_b16 v[148:149], v6 offset:1280
    ds_read_b64_tr_b16 v[152:153], v6 offset:1536
    ds_read_b64_tr_b16 v[156:157], v6 offset:1792
    ds_read_b64_tr_b16 v[160:161], v6 offset:2048
    ds_read_b64_tr_b16 v[164:165], v6 offset:2304
    ds_read_b64_tr_b16 v[168:169], v6 offset:2560
    ds_read_b64_tr_b16 v[172:173], v6 offset:2816
    ds_read_b64_tr_b16 v[176:177], v6 offset:3072
    ds_read_b64_tr_b16 v[180:181], v6 offset:3328
    ds_read_b64_tr_b16 v[184:185], v6 offset:3584
    ds_read_b64_tr_b16 v[188:189], v6 offset:3840
    s_add_u32 s46, s46, 8192
    s_cmp_eq_u32 s46, s42
    s_cselect_b32 s46, s41, s46
    s_waitcnt lgkmcnt(0)
    s_waitcnt vmcnt(5)
    s_call_b64 s[66:67], L_issue
    s_cmp_eq_u32 s7, 8
    s_cselect_b32 s96, s97, s96
    s_cselect_b32 s94, s6, s94
    s_mov_b32 m0, s94
    s_add_u32 s94, s94, s95
    s_mov_b64 exec, s[82:83]
    buffer_load_dwordx4 v12, s[84:87], s96 offen lds
    s_mov_b64 exec, -1
    s_add_u32 s96, s96, s98
    s_waitcnt vmcnt(5)
    s_waitcnt lgkmcnt(0)
    s_barrier
    s_cmp_eq_u32 s3, 0
    s_cbranch_scc0 L_cnt_done
    v_mov_b32 v10, 0
    v_mov_b32 v11, 1
    s_mov_b64 exec, 1
    global_atomic_add v10, v11, s[28:29]
    s_mov_b64 exec, -1
L_cnt_done:
    s_call_b64 s[66:67], L_issue
    s_cmp_eq_u32 s7, 9
    s_cselect_b32 s96, s97, s96
    s_cselect_b32 s94, s6, s94
    s_mov_b32 m0, s94
    s_add_u32 s94, s94, s95
    s_mov_b64 exec, s[82:83]
    buffer_load_dwordx4 v12, s[84:87], s96 offen lds
    s_mov_b64 exec, -1
    s_add_u32 s96, s96, s98
    v_add_u32 v6, s46, v5
    ds_read_b64_tr_b16 v[130:131], v6 offset:0
    ds_read_b64_tr_b16 v[134:135], v6 offset:256
    ds_read_b64_tr_b16 v[138:139], v6 offset:512
    ds_read_b64_tr_b16 v[142:143], v6 offset:768
    ds_read_b64_tr_b16 v[146:147], v6 offset:1024
    ds_read_b64_tr_b16 v[150:151], v6 offset:1280
    ds_read_b64_tr_b16 v[154:155], v6 offset:1536
    ds_read_b64_tr_b16 v[158:159], v6 offset:1792
    ds_read_b64_tr_b16 v[162:163], v6 offset:2048
    ds_read_b64_tr_b16 v[166:167], v6 offset:2304
    ds_read_b64_tr_b16 v[170:171], v6 offset:2560
    ds_read_b64_tr_b16 v[174:175], v6 offset:2816
    ds_read_b64_tr_b16 v[178:179], v6 offset:3072
    ds_read_b64_tr_b16 v[182:183], v6 offset:3328
    ds_read_b64_tr_b16 v[186:187], v6 offset:3584
    ds_read_b64_tr_b16 v[190:191], v6 offset:3840
    s_add_u32 s46, s46, 8192
    s_cmp_eq_u32 s46, s42
    s_cselect_b32 s46, s41, s46
    s_waitcnt lgkmcnt(0)
    s_waitcnt vmcnt(5)
    s_call_b64 s[66:67], L_issue
    s_cmp_eq_u32 s7, 10
    s_cselect_b32 s96, s97, s96
    s_cselect_b32 s94, s6, s94
    s_mov_b32 m0, s94
    s_add_u32 s94, s94, s95
    s_mov_b64 exec, s[82:83]
    buffer_load_dwordx4 v12, s[84:87], s96 offen lds
    s_mov_b64 exec, -1
    s_add_u32 s96, s96, s98
    s_waitcnt vmcnt(5)
    s_call_b64 s[66:67], L_issue
    s_cmp_eq_u32 s7, 11
    s_cselect_b32 s96, s97, s96
    s_cselect_b32 s94, s6, s94
    s_mov_b32 m0, s94
    s_add_u32 s94, s94, s95
    s_mov_b64 exec, s[82:83]
    buffer_load_dwordx4 v12, s[84:87], s96 offen lds
    s_mov_b64 exec, -1
    s_add_u32 s96, s96, s98
    v_add_u32 v6, s46, v5
    ds_read_b64_tr_b16 v[192:193], v6 offset:0
    ds_read_b64_tr_b16 v[196:197], v6 offset:256
    ds_read_b64_tr_b16 v[200:201], v6 offset:512
    ds_read_b64_tr_b16 v[204:205], v6 offset:768
    ds_read_b64_tr_b16 v[208:209], v6 offset:1024
    ds_read_b64_tr_b16 v[212:213], v6 offset:1280
    ds_read_b64_tr_b16 v[216:217], v6 offset:1536
    ds_read_b64_tr_b16 v[220:221], v6 offset:1792
    ds_read_b64_tr_b16 v[224:225], v6 offset:2048
    ds_read_b64_tr_b16 v[228:229], v6 offset:2304
    ds_read_b64_tr_b16 v[232:233], v6 offset:2560
    ds_read_b64_tr_b16 v[236:237], v6 offset:2816
    ds_read_b64_tr_b16 v[240:241], v6 offset:3072
    ds_read_b64_tr_b16 v[244:245], v6 offset:3328
    ds_read_b64_tr_b16 v[248:249], v6 offset:3584
    ds_read_b64_tr_b16 v[252:253], v6 offset:3840
    s_add_u32 s46, s46, 8192
    s_cmp_eq_u32 s46, s42
    s_cselect_b32 s46, s41, s46
    s_waitcnt lgkmcnt(0)
    s_waitcnt vmcnt(5)
    s_call_b64 s[66:67], L_issue
    s_cmp_eq_u32 s7, 12
    s_cselect_b32 s96, s97, s96
    s_cselect_b32 s94, s6, s94
    s_mov_b32 m0, s94
    s_add_u32 s94, s94, s95
    s_mov_b64 exec, s[82:83]
    buffer_load_dwordx4 v12, s[84:87], s96 offen lds
    s_mov_b64 exec, -1
    s_add_u32 s96, s96, s98
    s_waitcnt vmcnt(5)
    s_call_b64 s[66:67], L_issue
    s_cmp_eq_u32 s7, 13
    s_cselect_b32 s96, s97, s96
    s_cselect_b32 s94, s6, s94
    s_mov_b32 m0, s94
    s_add_u32 s94, s94, s95
    s_mov_b64 exec, s[82:83]
    buffer_load_dwordx4 v12, s[84:87], s96 offen lds
    s_mov_b64 exec, -1
    s_add_u32 s96, s96, s98
    v_add_u32 v6, s46, v5
    ds_read_b64_tr_b16 v[194:195], v6 offset:0
    ds_read_b64_tr_b16 v[198:199], v6 offset:256
    ds_read_b64_tr_b16 v[202:203], v6 offset:512
    ds_read_b64_tr_b16 v[206:207], v6 offset:768
    ds_read_b64_tr_b16 v[210:211], v6 offset:1024
    ds_read_b64_tr_b16 v[214:215], v6 offset:1280
    ds_read_b64_tr_b16 v[218:219], v6 offset:1536
    ds_read_b64_tr_b16 v[222:223], v6 offset:1792
    ds_read_b64_tr_b16 v[226:227], v6 offset:2048
    ds_read_b64_tr_b16 v[230:231], v6 offset:2304
    ds_read_b64_tr_b16 v[234:235], v6 offset:2560
    ds_read_b64_tr_b16 v[238:239], v6 offset:2816
    ds_read_b64_tr_b16 v[242:243], v6 offset:3072
    ds_read_b64_tr_b16 v[246:247], v6 offset:3328
    ds_read_b64_tr_b16 v[250:251], v6 offset:3584
    ds_read_b64_tr_b16 v[254:255], v6 offset:3840
    s_add_u32 s46, s46, 8192
    s_cmp_eq_u32 s46, s42
    s_cselect_b32 s46, s41, s46
    s_waitcnt lgkmcnt(0)
    s_waitcnt vmcnt(5)
    s_call_b64 s[66:67], L_issue
    s_cmp_eq_u32 s48, 1
    s_cselect_b32 s86, s86, 0
    s_cselect_b32 s94, s94, s53
    s_cselect_b32 s95, s95, 0
    s_mov_b32 m0, s94
    s_add_u32 s94, s94, s95
    s_mov_b64 exec, s[82:83]
    buffer_load_dwordx4 v12, s[84:87], s96 offen lds
    s_mov_b64 exec, -1
    s_add_u32 s96, s96, s98
    s_waitcnt vmcnt(5)
    s_call_b64 s[66:67], L_issue
    s_mov_b32 m0, s94
    s_add_u32 s94, s94, s95
    s_mov_b64 exec, s[82:83]
    buffer_load_dwordx4 v12, s[84:87], s96 offen lds
    s_mov_b64 exec, -1
    s_add_u32 s96, s96, s98
    v_add_u32 v6, s46, v5
    ds_read_b64_tr_b16 a[0:1], v6 offset:0
    ds_read_b64_tr_b16 a[4:5], v6 offset:256
    ds_read_b64_tr_b16 a[8:9], v6 offset:512
    ds_read_b64_tr_b16 a[12:13], v6 offset:768
    ds_read_b64_tr_b16 a[16:17], v6 offset:1024
    ds_read_b64_tr_b16 a[20:21], v6 offset:1280
    ds_read_b64_tr_b16 a[24:25], v6 offset:1536
    ds_read_b64_tr_b16 a[28:29], v6 offset:1792
    ds_read_b64_tr_b16 a[32:33], v6 offset:2048
    ds_read_b64_tr_b16 a[36:37], v6 offset:2304
    ds_read_b64_tr_b16 a[40:41], v6 offset:2560
    ds_read_b64_tr_b16 a[44:45], v6 offset:2816
    ds_read_b64_tr_b16 a[48:49], v6 offset:3072
    ds_read_b64_tr_b16 a[52:53], v6 offset:3328
    ds_read_b64_tr_b16 a[56:57], v6 offset:3584
    ds_read_b64_tr_b16 a[60:61], v6 offset:3840
    s_add_u32 s46, s46, 8192
    s_cmp_eq_u32 s46, s42
    s_cselect_b32 s46, s41, s46
    s_waitcnt lgkmcnt(0)
    s_waitcnt vmcnt(5)
    s_call_b64 s[66:67], L_issue
    s_waitcnt vmcnt(4)
    s_call_b64 s[66:67], L_issue
    v_add_u32 v6, s46, v5
    ds_read_b64_tr_b16 a[2:3], v6 offset:0
    ds_read_b64_tr_b16 a[6:7], v6 offset:256
    ds_read_b64_tr_b16 a[10:11], v6 offset:512
    ds_read_b64_tr_b16 a[14:15], v6 offset:768
    ds_read_b64_tr_b16 a[18:19], v6 offset:1024
    ds_read_b64_tr_b16 a[22:23], v6 offset:1280
    ds_read_b64_tr_b16 a[26:27], v6 offset:1536
    ds_read_b64_tr_b16 a[30:31], v6 offset:1792
    ds_read_b64_tr_b16 a[34:35], v6 offset:2048
    ds_read_b64_tr_b16 a[38:39], v6 offset:2304
    ds_read_b64_tr_b16 a[42:43], v6 offset:2560
    ds_read_b64_tr_b16 a[46:47], v6 offset:2816
    ds_read_b64_tr_b16 a[50:51], v6 offset:3072
    ds_read_b64_tr_b16 a[54:55], v6 offset:3328
    ds_read_b64_tr_b16 a[58:59], v6 offset:3584
    ds_read_b64_tr_b16 a[62:63], v6 offset:3840
    s_add_u32 s46, s46, 8192
    s_cmp_eq_u32 s46, s42
    s_cselect_b32 s46, s41, s46
    s_waitcnt lgkmcnt(0)
    s_waitcnt vmcnt(4)
    s_call_b64 s[66:67], L_issue
    s_waitcnt vmcnt(4)
    s_call_b64 s[66:67], L_issue
    v_add_u32 v6, s46, v5
    ds_read_b64_tr_b16 a[64:65], v6 offset:0
    ds_read_b64_tr_b16 a[68:69], v6 offset:256
    ds_read_b64_tr_b16 a[72:73], v6 offset:512
    ds_read_b64_tr_b16 a[76:77], v6 offset:768
    ds_read_b64_tr_b16 a[80:81], v6 offset:1024
    ds_read_b64_tr_b16 a[84:85], v6 offset:1280
    ds_read_b64_tr_b16 a[88:89], v6 offset:1536
    ds_read_b64_tr_b16 a[92:93], v6 offset:1792
    ds_read_b64_tr_b16 a[96:97], v6 offset:2048
    ds_read_b64_tr_b16 a[100:101], v6 offset:2304
    ds_read_b64_tr_b16 a[104:105], v6 offset:2560
    ds_read_b64_tr_b16 a[108:109], v6 offset:2816
    ds_read_b64_tr_b16 a[112:113], v6 offset:3072
    ds_read_b64_tr_b16 a[116:117], v6 offset:3328
    ds_read_b64_tr_b16 a[120:121], v6 offset:3584
    ds_read_b64_tr_b16 a[124:125], v6 offset:3840
    s_add_u32 s46, s46, 8192
    s_cmp_eq_u32 s46, s42
    s_cselect_b32 s46, s41, s46
    s_waitcnt lgkmcnt(0)
    s_waitcnt vmcnt(4)
    s_call_b64 s[66:67], L_issue
    s_waitcnt vmcnt(4)
    s_cmp_eq_u32 s48, 4
    s_cbranch_scc0 L_noq1
    s_barrier
    s_call_b64 s[88:89], L_stageD_prep
    s_lshl_b32 s70, s49, 7
    s_lshl_b32 s71, s3, 5
    s_add_u32 s78, s30, 0xce000
    s_addc_u32 s79, s31, 0
    s_add_u32 s78, s78, s70
    s_addc_u32 s79, s79, 0
    s_call_b64 s[88:89], L_stageD_rest
L_noq1:
    s_call_b64 s[66:67], L_issue
    v_lshrrev_b32 v5, 5, v0
    v_lshlrev_b32 v5, 12, v5
    v_and_b32 v6, 31, v0
    v_lshl_add_u32 v5, v6, 3, v5
    v_add_u32 v6, s46, v5
    ds_read_b64_tr_b16 a[66:67], v6 offset:0
    ds_read_b64_tr_b16 a[70:71], v6 offset:256
    ds_read_b64_tr_b16 a[74:75], v6 offset:512
    ds_read_b64_tr_b16 a[78:79], v6 offset:768
    ds_read_b64_tr_b16 a[82:83], v6 offset:1024
    ds_read_b64_tr_b16 a[86:87], v6 offset:1280
    ds_read_b64_tr_b16 a[90:91], v6 offset:1536
    ds_read_b64_tr_b16 a[94:95], v6 offset:1792
    ds_read_b64_tr_b16 a[98:99], v6 offset:2048
    ds_read_b64_tr_b16 a[102:103], v6 offset:2304
    ds_read_b64_tr_b16 a[106:107], v6 offset:2560
    ds_read_b64_tr_b16 a[110:111], v6 offset:2816
    ds_read_b64_tr_b16 a[114:115], v6 offset:3072
    ds_read_b64_tr_b16 a[118:119], v6 offset:3328
    ds_read_b64_tr_b16 a[122:123], v6 offset:3584
    ds_read_b64_tr_b16 a[126:127], v6 offset:3840
    s_add_u32 s46, s46, 8192
    s_cmp_eq_u32 s46, s42
    s_cselect_b32 s46, s41, s46
    s_waitcnt lgkmcnt(0)
    s_waitcnt vmcnt(4)
    v_mov_b32 v37, 0
    global_load_dword v36, v37, s[28:29] sc1
    s_call_b64 s[66:67], L_issue
    s_waitcnt vmcnt(4)
    s_call_b64 s[66:67], L_issue
    v_add_u32 v6, s46, v5
    ds_read_b64_tr_b16 a[128:129], v6 offset:0
    ds_read_b64_tr_b16 a[132:133], v6 offset:256
    ds_read_b64_tr_b16 a[136:137], v6 offset:512
    ds_read_b64_tr_b16 a[140:141], v6 offset:768
    ds_read_b64_tr_b16 a[144:145], v6 offset:1024
    ds_read_b64_tr_b16 a[148:149], v6 offset:1280
    ds_read_b64_tr_b16 a[152:153], v6 offset:1536
    ds_read_b64_tr_b16 a[156:157], v6 offset:1792
    ds_read_b64_tr_b16 a[160:161], v6 offset:2048
    ds_read_b64_tr_b16 a[164:165], v6 offset:2304
    ds_read_b64_tr_b16 a[168:169], v6 offset:2560
    ds_read_b64_tr_b16 a[172:173], v6 offset:2816
    ds_read_b64_tr_b16 a[176:177], v6 offset:3072
    ds_read_b64_tr_b16 a[180:181], v6 offset:3328
    ds_read_b64_tr_b16 a[184:185], v6 offset:3584
    ds_read_b64_tr_b16 a[188:189], v6 offset:3840
    s_add_u32 s46, s46, 8192
    s_cmp_eq_u32 s46, s42
    s_cselect_b32 s46, s41, s46
    s_waitcnt lgkmcnt(0)
    s_waitcnt vmcnt(4)
    s_call_b64 s[66:67], L_issue
    s_waitcnt vmcnt(4)
    s_call_b64 s[66:67], L_issue
    v_add_u32 v6, s46, v5
    ds_read_b64_tr_b16 a[130:131], v6 offset:0
    ds_read_b64_tr_b16 a[134:135], v6 offset:256
    ds_read_b64_tr_b16 a[138:139], v6 offset:512
    ds_read_b64_tr_b16 a[142:143], v6 offset:768
    ds_read_b64_tr_b16 a[146:147], v6 offset:1024
    ds_read_b64_tr_b16 a[150:151], v6 offset:1280
    ds_read_b64_tr_b16 a[154:155], v6 offset:1536
    ds_read_b64_tr_b16 a[158:159], v6 offset:1792
    ds_read_b64_tr_b16 a[162:163], v6 offset:2048
    ds_read_b64_tr_b16 a[166:167], v6 offset:2304
    ds_read_b64_tr_b16 a[170:171], v6 offset:2560
    ds_read_b64_tr_b16 a[174:175], v6 offset:2816
    ds_read_b64_tr_b16 a[178:179], v6 offset:3072
    ds_read_b64_tr_b16 a[182:183], v6 offset:3328
    ds_read_b64_tr_b16 a[186:187], v6 offset:3584
    ds_read_b64_tr_b16 a[190:191], v6 offset:3840
    s_add_u32 s46, s46, 8192
    s_cmp_eq_u32 s46, s42
    s_cselect_b32 s46, s41, s46
    s_waitcnt lgkmcnt(0)
    s_waitcnt vmcnt(4)
    s_mov_b32 s100, s81
    v_cmp_gt_u32 vcc, 256, v36
    s_cbranch_vccnz Lnq_2
    s_add_u32 s100, s81, 1
    s_lshl_b32 s71, s50, 9
    s_add_u32 s76, s30, 0xce000
    s_addc_u32 s77, s31, 0
    s_add_u32 s76, s76, s71
    s_addc_u32 s77, s77, 0
    v_and_b32 v37, 31, v0
    v_lshlrev_b32 v37, 4, v37
    global_load_dwordx4 v[32:35], v37, s[76:77] sc1
Lnq_2:
    s_call_b64 s[66:67], L_issue
    s_waitcnt vmcnt(4)
    s_call_b64 s[66:67], L_issue
    v_add_u32 v6, s46, v5
    ds_read_b64_tr_b16 a[192:193], v6 offset:0
    ds_read_b64_tr_b16 a[196:197], v6 offset:256
    ds_read_b64_tr_b16 a[200:201], v6 offset:512
    ds_read_b64_tr_b16 a[204:205], v6 offset:768
    ds_read_b64_tr_b16 a[208:209], v6 offset:1024
    ds_read_b64_tr_b16 a[212:213], v6 offset:1280
    ds_read_b64_tr_b16 a[216:217], v6 offset:1536
    ds_read_b64_tr_b16 a[220:221], v6 offset:1792
    ds_read_b64_tr_b16 a[224:225], v6 offset:2048
    ds_read_b64_tr_b16 a[228:229], v6 offset:2304
    ds_read_b64_tr_b16 a[232:233], v6 offset:2560
    ds_read_b64_tr_b16 a[236:237], v6 offset:2816
    ds_read_b64_tr_b16 a[240:241], v6 offset:3072
    ds_read_b64_tr_b16 a[244:245], v6 offset:3328
    ds_read_b64_tr_b16 a[248:249], v6 offset:3584
    ds_read_b64_tr_b16 a[252:253], v6 offset:3840
    s_add_u32 s46, s46, 8192
    s_cmp_eq_u32 s46, s42
    s_cselect_b32 s46, s41, s46
    s_waitcnt lgkmcnt(0)
    s_waitcnt vmcnt(4)
    s_call_b64 s[66:67], L_issue
    s_waitcnt vmcnt(4)
    s_call_b64 s[66:67], L_issue
    v_add_u32 v6, s46, v5
    ds_read_b64_tr_b16 a[194:195], v6 offset:0
    ds_read_b64_tr_b16 a[198:199], v6 offset:256
    ds_read_b64_tr_b16 a[202:203], v6 offset:512
    ds_read_b64_tr_b16 a[206:207], v6 offset:768
    ds_read_b64_tr_b16 a[210:211], v6 offset:1024
    ds_read_b64_tr_b16 a[214:215], v6 offset:1280
    ds_read_b64_tr_b16 a[218:219], v6 offset:1536
    ds_read_b64_tr_b16 a[222:223], v6 offset:1792
    ds_read_b64_tr_b16 a[226:227], v6 offset:2048
    ds_read_b64_tr_b16 a[230:231], v6 offset:2304
    ds_read_b64_tr_b16 a[234:235], v6 offset:2560
    ds_read_b64_tr_b16 a[238:239], v6 offset:2816
    ds_read_b64_tr_b16 a[242:243], v6 offset:3072
    ds_read_b64_tr_b16 a[246:247], v6 offset:3328
    ds_read_b64_tr_b16 a[250:251], v6 offset:3584
    ds_read_b64_tr_b16 a[254:255], v6 offset:3840
    s_add_u32 s46, s46, 8192
    s_cmp_eq_u32 s46, s42
    s_cselect_b32 s46, s41, s46
    s_waitcnt lgkmcnt(0)
L_pass:
    s_cmp_eq_u32 s47, 0
    s_cbranch_scc0 L_gq
    s_cmp_eq_u32 s100, 1
    s_cbranch_scc0 L_gq_slow
    v_max3_u32 v36, v32, v33, v34
    v_max_u32 v36, v36, v35
    v_cmp_eq_u32 vcc, -1, v36
    v_and_b32 v8, 31, v0
    v_lshlrev_b32 v8, 4, v8
    s_cbranch_vccz L_gq_write
L_gq_slow:
    v_mov_b32 v8, 0
    s_mov_b32 s55, 0
Lc_3:
    global_load_dword v9, v8, s[28:29] sc1
    s_waitcnt vmcnt(0)
    v_cmp_gt_u32 vcc, 256, v9
    s_cbranch_vccz Lcd_4
    s_add_u32 s55, s55, 1
    s_cmp_lt_u32 s55, 262144
    s_cbranch_scc1 Lc_3
Lcd_4:
L_gq:
    s_cmp_eq_u32 s47, 1
    s_cbranch_scc0 L_gq_p0
    s_cmp_eq_u32 s3, 0
    s_cbranch_scc0 L_gq_bar
    s_lshl_b32 s71, s50, 9
    s_add_u32 s76, s30, 0xd0000
    s_addc_u32 s77, s31, 0
    s_add_u32 s76, s76, s71
    s_addc_u32 s77, s77, 0
    s_lshl_b32 s70, s50, 7
    s_add_u32 s78, s30, 0xd2000
    s_addc_u32 s79, s31, 0
    s_add_u32 s78, s78, s70
    s_addc_u32 s79, s79, 0
    v_and_b32 v8, 31, v0
    v_lshlrev_b32 v8, 4, v8
    v_mov_b32 v9, 0
    s_mov_b32 s55, 0
    global_load_dwordx4 v[20:23], v8, s[76:77] sc1
    global_load_dwordx2 v[24:25], v9, s[78:79] sc1
Qq_5:
    global_load_dwordx4 v[26:29], v8, s[76:77] sc1
    global_load_dwordx2 v[30:31], v9, s[78:79] sc1
    s_waitcnt vmcnt(2)
    v_max3_u32 v10, v20, v21, v22
    v_max3_u32 v10, v10, v23, v24
    v_max_u32 v10, v10, v25
    v_cmp_eq_u32 vcc, -1, v10
    s_cbranch_vccz Qqa_6
    global_load_dwordx4 v[20:23], v8, s[76:77] sc1
    global_load_dwordx2 v[24:25], v9, s[78:79] sc1
    s_waitcnt vmcnt(2)
    v_max3_u32 v10, v26, v27, v28
    v_max3_u32 v10, v10, v29, v30
    v_max_u32 v10, v10, v31
    v_cmp_eq_u32 vcc, -1, v10
    s_cbranch_vccz Qqb_7
    s_add_u32 s55, s55, 1
    s_cmp_lt_u32 s55, 262144
    s_cbranch_scc1 Qq_5
    s_waitcnt vmcnt(0)
Qqa_6:
    v_mov_b32 v32, v20
    v_mov_b32 v33, v21
    v_mov_b32 v34, v22
    v_mov_b32 v35, v23
    v_mov_b32 v36, v24
    v_mov_b32 v37, v25
    s_branch Qqd_8
Qqb_7:
    v_mov_b32 v32, v26
    v_mov_b32 v33, v27
    v_mov_b32 v34, v28
    v_mov_b32 v35, v29
    v_mov_b32 v36, v30
    v_mov_b32 v37, v31
Qqd_8:
    ds_write_b128 v8, v[32:35] offset:0
    ds_write_b128 v8, v[32:35] offset:512
    ds_write_b128 v8, v[32:35] offset:1024
    ds_write_b128 v8, v[32:35] offset:1536
    v_mov_b32 v9, 2720
    ds_write_b64 v9, v[36:37]
    s_waitcnt lgkmcnt(0)
L_gq_bar:
    s_barrier
    v_mov_b32 v9, 2720
    ds_read_b64 v[38:39], v9
    s_waitcnt lgkmcnt(0)
    s_cmp_eq_u32 s47, 1
    s_cbranch_scc0 Lns_9
    v_readfirstlane_b32 s70, v38
    v_readfirstlane_b32 s71, v39
    s_nop 3
    s_and_b32 s71, s71, 1
    s_and_b32 s70, s70, 1
    s_xor_b32 s1, s70, s71
    s_lshr_b32 s72, s2, 1
    s_lshr_b32 s73, s2, 2
    s_xor_b32 s72, s72, s73
    s_and_b32 s72, s72, 1
    s_xor_b32 s70, s70, s72
    s_xor_b32 s71, s71, s72
    s_lshl_b32 s70, s70, 13
    s_lshl_b32 s71, s71, 13
    s_xor_b32 s73, s2, 4
    s_cmp_lt_u32 s3, 2
    s_cselect_b32 s73, s2, s73
    s_mul_i32 s0, s73, 3
    s_and_b32 s0, s0, 63
    s_mul_i32 s0, s0, 16384
    s_sub_i32 s73, s73, s2
    s_lshl_b32 s73, s73, 20
    s_add_i32 s70, s70, s73
    s_add_i32 s71, s71, s73
    s_ashr_i32 s72, s70, 31
    s_add_u32 s10, s32, s70
    s_addc_u32 s11, s33, s72
    s_and_b32 s11, s11, 0xffff
    s_ashr_i32 s72, s71, 31
    s_add_u32 s12, s34, s71
    s_addc_u32 s13, s35, s72
    s_and_b32 s13, s13, 0xffff
Lns_9:
    s_branch L_gq_end
L_gq_p0:
    s_lshl_b32 s70, s47, 13
    s_lshl_b32 s71, s50, 9
    s_add_u32 s76, s30, 0xce000
    s_addc_u32 s77, s31, 0
    s_add_u32 s76, s76, s70
    s_addc_u32 s77, s77, 0
    s_add_u32 s76, s76, s71
    s_addc_u32 s77, s77, 0
    v_and_b32 v8, 31, v0
    v_lshlrev_b32 v8, 4, v8
    s_lshl_b32 s70, s50, 7
    s_add_u32 s78, s30, 0xd2000
    s_addc_u32 s79, s31, 0
    s_add_u32 s78, s78, s70
    s_addc_u32 s79, s79, 0
    s_cmp_eq_u32 s47, 0
    s_cselect_b32 s78, s76, s78
    s_cselect_b32 s79, s77, s79
    v_mov_b32 v37, 0
    s_mov_b32 s55, 0
Pq_10:
    global_load_dwordx4 v[32:35], v8, s[76:77] sc1
    global_load_dwordx2 v[38:39], v37, s[78:79] sc1
    s_waitcnt vmcnt(0)
    v_max3_u32 v36, v32, v33, v34
    v_max3_u32 v36, v36, v35, v38
    v_max_u32 v36, v36, v39
    v_cmp_eq_u32 vcc, -1, v36
    s_cbranch_vccz Pqd_11
    s_add_u32 s55, s55, 1
    s_cmp_lt_u32 s55, 262144
    s_cbranch_scc1 Pq_10
Pqd_11:
L_gq_write:
    s_lshl_b32 s70, s3, 9
    v_add_u32 v8, s70, v8
    ds_write_b128 v8, v[32:35] offset:0
    s_waitcnt lgkmcnt(0)
L_gq_end:
    v_bfe_u32 v5, v0, 3, 1
    v_lshlrev_b32 v5, 12, v5
    v_and_b32 v6, 7, v0
    v_lshl_add_u32 v5, v6, 9, v5
    v_lshrrev_b32 v16, 4, v0
    v_and_b32 v18, 3, v0
    v_xor_b32 v18, v18, v16
    v_lshl_add_u32 v5, v18, 4, v5
    v_bfe_u32 v18, v0, 2, 1
    v_lshlrev_b32 v18, 6, v18
    v_sub_u32 v19, v5, v18
    v_add_u32 v5, v5, v18
    v_mov_b32 v18, v19
    v_lshlrev_b32 v16, 4, v16
    s_lshl_b32 s70, s3, 9
    s_add_u32 s70, s70, 0
    v_add_u32 v16, s70, v16
    v_mov_b32 v17, 2176
    v_mov_b32 v8, 0
    v_mov_b32 v9, 0
    v_mov_b32 v10, 0
    v_mov_b32 v11, 0
    v_mov_b32 v12, 0
    v_mov_b32 v13, 0
    v_mov_b32 v14, 0
    v_mov_b32 v15, 0
    s_mov_b32 s80, 0
    s_cmp_eq_u32 s47, 0
    s_cbranch_scc1 L_k0
    s_cmp_eq_u32 s3, 0
    s_cbranch_scc1 Kskip_12
    s_waitcnt vmcnt(0)
    s_branch Kskip_12
L_k0:
    s_waitcnt vmcnt(4)
    s_call_b64 s[66:67], L_issue
    s_waitcnt vmcnt(4)
    s_call_b64 s[66:67], L_issue
Kskip_12:
    s_lshl_b64 s[64:65], s[56:57], s80
    v_add_u32 v6, s46, v5
    v_add_u32 v19, s46, v18
    v_cndmask_b32 v7, v17, v16, s[64:65]
    ds_read_b128 v[32:35], v7 offset:0
    ds_read_b128 v[48:51], v6 offset:0
    ds_read_b128 v[36:39], v7 offset:64
    ds_read_b128 v[52:55], v19 offset:64
    ds_read_b128 v[40:43], v7 offset:128
    ds_read_b128 v[56:59], v6 offset:128
    ds_read_b128 v[44:47], v7 offset:192
    ds_read_b128 v[60:63], v19 offset:192
    s_waitcnt lgkmcnt(0)
    v_mfma_f32_16x16x32_bf16 v[8:11], v[32:35], v[48:51], v[8:11]
    v_mfma_f32_16x16x32_bf16 v[8:11], v[36:39], v[52:55], v[8:11]
    v_mfma_f32_16x16x32_bf16 v[8:11], v[40:43], v[56:59], v[8:11]
    v_mfma_f32_16x16x32_bf16 v[8:11], v[44:47], v[60:63], v[8:11]
    ds_read_b128 v[32:35], v7 offset:256
    ds_read_b128 v[48:51], v6 offset:256
    ds_read_b128 v[36:39], v7 offset:320
    ds_read_b128 v[52:55], v19 offset:320
    ds_read_b128 v[40:43], v7 offset:384
    ds_read_b128 v[56:59], v6 offset:384
    ds_read_b128 v[44:47], v7 offset:448
    ds_read_b128 v[60:63], v19 offset:448
    s_waitcnt lgkmcnt(0)
    v_mfma_f32_16x16x32_bf16 v[8:11], v[32:35], v[48:51], v[8:11]
    v_mfma_f32_16x16x32_bf16 v[8:11], v[36:39], v[52:55], v[8:11]
    v_mfma_f32_16x16x32_bf16 v[8:11], v[40:43], v[56:59], v[8:11]
    v_mfma_f32_16x16x32_bf16 v[8:11], v[44:47], v[60:63], v[8:11]
    s_add_u32 s46, s46, 8192
    s_cmp_eq_u32 s46, s42
    s_cselect_b32 s46, s41, s46
    s_add_u32 s80, s80, 1
    s_and_b32 s80, s80, 15
    s_cbranch_scc1 L_k0
L_k1:
    s_waitcnt vmcnt(4)
    s_call_b64 s[66:67], L_issue
    s_waitcnt vmcnt(4)
    s_call_b64 s[66:67], L_issue
    s_lshl_b64 s[64:65], s[56:57], s80
    v_add_u32 v6, s46, v5
    v_add_u32 v19, s46, v18
    v_cndmask_b32 v7, v17, v16, s[64:65]
    ds_read_b128 v[32:35], v7 offset:0
    ds_read_b128 v[48:51], v6 offset:0
    ds_read_b128 v[36:39], v7 offset:64
    ds_read_b128 v[52:55], v19 offset:64
    ds_read_b128 v[40:43], v7 offset:128
    ds_read_b128 v[56:59], v6 offset:128
    ds_read_b128 v[44:47], v7 offset:192
    ds_read_b128 v[60:63], v19 offset:192
    s_waitcnt lgkmcnt(0)
    v_mfma_f32_16x16x32_bf16 v[12:15], v[32:35], v[48:51], v[12:15]
    v_mfma_f32_16x16x32_bf16 v[12:15], v[36:39], v[52:55], v[12:15]
    v_mfma_f32_16x16x32_bf16 v[12:15], v[40:43], v[56:59], v[12:15]
    v_mfma_f32_16x16x32_bf16 v[12:15], v[44:47], v[60:63], v[12:15]
    ds_read_b128 v[32:35], v7 offset:256
    ds_read_b128 v[48:51], v6 offset:256
    ds_read_b128 v[36:39], v7 offset:320
    ds_read_b128 v[52:55], v19 offset:320
    ds_read_b128 v[40:43], v7 offset:384
    ds_read_b128 v[56:59], v6 offset:384
    ds_read_b128 v[44:47], v7 offset:448
    ds_read_b128 v[60:63], v19 offset:448
    s_waitcnt lgkmcnt(0)
    v_mfma_f32_16x16x32_bf16 v[12:15], v[32:35], v[48:51], v[12:15]
    v_mfma_f32_16x16x32_bf16 v[12:15], v[36:39], v[52:55], v[12:15]
    v_mfma_f32_16x16x32_bf16 v[12:15], v[40:43], v[56:59], v[12:15]
    v_mfma_f32_16x16x32_bf16 v[12:15], v[44:47], v[60:63], v[12:15]
    s_add_u32 s46, s46, 8192
    s_cmp_eq_u32 s46, s42
    s_cselect_b32 s46, s41, s46
    s_add_u32 s80, s80, 1
    s_and_b32 s80, s80, 15
    s_cbranch_scc1 L_k1
    s_nop 7
    v_cvt_pk_bf16_f32 v36, v8, v9
    v_cvt_pk_bf16_f32 v37, v10, v11
    v_cvt_pk_bf16_f32 v38, v12, v13
    v_cvt_pk_bf16_f32 v39, v14, v15
    s_cmp_eq_u32 s47, 1
    s_cbranch_scc0 Lnx_13
    s_cmp_eq_u32 s1, 1
    s_cbranch_scc0 Lnx_13
    v_lshlrev_b32 v40, 4, v0
    v_mov_b32 v41, -2
    v_min_u32 v44, v36, v41
    v_min_u32 v45, v37, v41
    v_min_u32 v46, v38, v41
    v_min_u32 v47, v39, v41
    s_lshl_b32 s70, s2, 12
    s_lshl_b32 s71, s3, 10
    s_add_u32 s76, s30, 0x300000
    s_addc_u32 s77, s31, 0
    s_add_u32 s76, s76, s70
    s_addc_u32 s77, s77, 0
    s_add_u32 s76, s76, s71
    s_addc_u32 s77, s77, 0
    global_store_dwordx4 v40, v[44:47], s[76:77] sc1
    s_xor_b32 s70, s2, 4
    s_lshl_b32 s70, s70, 12
    s_xor_b32 s71, s3, 2
    s_lshl_b32 s71, s71, 10
    s_add_u32 s76, s30, 0x300000
    s_addc_u32 s77, s31, 0
    s_add_u32 s76, s76, s70
    s_addc_u32 s77, s77, 0
    s_add_u32 s76, s76, s71
    s_addc_u32 s77, s77, 0
    s_mov_b32 s55, 0
Px7_14:
    global_load_dwordx4 v[48:51], v40, s[76:77] sc1
    s_waitcnt vmcnt(0)
    v_max3_u32 v52, v48, v49, v50
    v_max_u32 v52, v52, v51
    v_cmp_eq_u32 vcc, -1, v52
    s_cbranch_vccz Px7d_15
    s_add_u32 s55, s55, 1
    s_cmp_lt_u32 s55, 262144
    s_cbranch_scc1 Px7_14
Px7d_15:
    v_mov_b32 v52, 0xffff0000
    v_mov_b32 v53, 0xffff0000
    s_mov_b64 exec, 0xffff
    v_mov_b32 v52, 0
    s_mov_b32 exec_lo, 0
    s_mov_b32 exec_hi, -1
    v_mov_b32 v53, -1
    s_mov_b64 exec, -1
    v_bfi_b32 v36, v52, v48, v36
    v_bfi_b32 v37, v52, v49, v37
    v_bfi_b32 v38, v53, v50, v38
    v_bfi_b32 v39, v53, v51, v39
Lnx_13:
    v_lshlrev_b32 v8, 16, v36
    v_and_b32 v9, 0xffff0000, v36
    v_lshlrev_b32 v10, 16, v37
    v_and_b32 v11, 0xffff0000, v37
    v_lshlrev_b32 v12, 16, v38
    v_and_b32 v13, 0xffff0000, v38
    v_lshlrev_b32 v14, 16, v39
    v_and_b32 v15, 0xffff0000, v39
    v_max3_f32 v32, v8, v9, v10
    v_max3_f32 v32, v32, v11, v12
    v_max3_f32 v32, v32, v13, v14
    v_max_f32 v32, v32, v15
    s_nop 1
    v_max_f32_dpp v32, v32, v32 row_ror:8 row_mask:0xf bank_mask:0xf
    s_nop 1
    v_max_f32_dpp v32, v32, v32 row_ror:4 row_mask:0xf bank_mask:0xf
    s_nop 1
    v_max_f32_dpp v32, v32, v32 row_ror:2 row_mask:0xf bank_mask:0xf
    s_nop 1
    v_max_f32_dpp v32, v32, v32 row_ror:1 row_mask:0xf bank_mask:0xf
    v_mov_b32 v33, v32
    s_nop 1
    v_permlane16_swap_b32 v32, v33
    s_nop 0
    v_max_f32 v32, v32, v33
    v_mov_b32 v33, v32
    s_nop 1
    v_permlane32_swap_b32 v32, v33
    s_nop 0
    v_max_f32 v32, v32, v33
    s_lshl_b32 s70, s3, 2
    s_add_u32 s70, s70, 2688
    v_mov_b32 v33, s70
    ds_write_b32 v33, v32
    s_waitcnt lgkmcnt(0)
    s_barrier
    v_mov_b32 v33, 2688
    ds_read_b128 v[36:39], v33
    s_waitcnt lgkmcnt(0)
    v_max3_f32 v32, v36, v37, v38
    v_max_f32 v32, v32, v39
    s_mov_b32 s70, 0x3db8aa3b
    v_sub_f32 v8, v8, v32
    v_sub_f32 v9, v9, v32
    v_sub_f32 v10, v10, v32
    v_sub_f32 v11, v11, v32
    v_sub_f32 v12, v12, v32
    v_sub_f32 v13, v13, v32
    v_sub_f32 v14, v14, v32
    v_sub_f32 v15, v15, v32
    v_mul_f32 v8, s70, v8
    v_mul_f32 v9, s70, v9
    v_mul_f32 v10, s70, v10
    v_mul_f32 v11, s70, v11
    v_mul_f32 v12, s70, v12
    v_mul_f32 v13, s70, v13
    v_mul_f32 v14, s70, v14
    v_mul_f32 v15, s70, v15
    v_exp_f32 v8, v8
    v_exp_f32 v9, v9
    v_exp_f32 v10, v10
    v_exp_f32 v11, v11
    v_exp_f32 v12, v12
    v_exp_f32 v13, v13
    v_exp_f32 v14, v14
    v_exp_f32 v15, v15
    s_nop 0
    v_lshrrev_b32 v33, 4, v0
    v_lshlrev_b32 v33, 7, v33
    v_and_b32 v34, 15, v0
    v_lshl_add_u32 v33, v34, 1, v33
    s_lshl_b32 s70, s3, 10
    s_add_u32 s70, s70, 3072
    v_add_u32 v33, s70, v33
    v_cvt_pk_bf16_f32 v36, v8, v9
    ds_write_b16 v33, v36 offset:0
    ds_write_b16_d16_hi v33, v36 offset:32
    v_cvt_pk_bf16_f32 v37, v10, v11
    ds_write_b16 v33, v37 offset:64
    ds_write_b16_d16_hi v33, v37 offset:96
    v_cvt_pk_bf16_f32 v38, v12, v13
    ds_write_b16 v33, v38 offset:512
    ds_write_b16_d16_hi v33, v38 offset:544
    v_cvt_pk_bf16_f32 v39, v14, v15
    ds_write_b16 v33, v39 offset:576
    ds_write_b16_d16_hi v33, v39 offset:608
    v_add_f32 v34, v8, v9
    v_add_f32 v35, v10, v11
    v_add_f32 v40, v12, v13
    v_add_f32 v41, v14, v15
    v_add_f32 v34, v34, v35
    v_add_f32 v40, v40, v41
    v_add_f32 v34, v34, v40
    s_nop 1
    v_add_f32_dpp v34, v34, v34 row_ror:8 row_mask:0xf bank_mask:0xf
    s_nop 1
    v_add_f32_dpp v34, v34, v34 row_ror:4 row_mask:0xf bank_mask:0xf
    s_nop 1
    v_add_f32_dpp v34, v34, v34 row_ror:2 row_mask:0xf bank_mask:0xf
    s_nop 1
    v_add_f32_dpp v34, v34, v34 row_ror:1 row_mask:0xf bank_mask:0xf
    v_mov_b32 v35, v34
    s_nop 1
    v_permlane16_swap_b32 v34, v35
    s_nop 0
    v_add_f32 v34, v34, v35
    v_mov_b32 v35, v34
    s_nop 1
    v_permlane32_swap_b32 v34, v35
    s_nop 0
    v_add_f32 v34, v34, v35
    v_mov_b32 v8, v34
    v_mov_b32 v9, v32
    s_waitcnt lgkmcnt(0)
    v_lshrrev_b32 v5, 5, v0
    v_lshlrev_b32 v5, 12, v5
    v_and_b32 v6, 31, v0
    v_lshl_add_u32 v5, v6, 3, v5
    v_lshrrev_b32 v7, 4, v0
    v_lshlrev_b32 v7, 3, v7
    s_lshl_b32 s70, s3, 10
    s_add_u32 s70, s70, 3072
    v_add_u32 v7, s70, v7
    v_mov_b32 v16, 0
    v_mov_b32 v17, 0
    v_mov_b32 v18, 0
    v_mov_b32 v19, 0
    v_mov_b32 v20, 0
    v_mov_b32 v21, 0
    v_mov_b32 v22, 0
    v_mov_b32 v23, 0
    v_mov_b32 v24, 0
    v_mov_b32 v25, 0
    v_mov_b32 v26, 0
    v_mov_b32 v27, 0
    v_mov_b32 v28, 0
    v_mov_b32 v29, 0
    v_mov_b32 v30, 0
    v_mov_b32 v31, 0
    s_getpc_b64 s[18:19]
L_pcref:
    s_add_u32 s18, s18, L_gapcode-L_pcref
    s_addc_u32 s19, s19, 0
    v_lshlrev_b32 v46, 7, v0
    s_waitcnt vmcnt(4)
    s_call_b64 s[66:67], L_issue
    s_waitcnt vmcnt(4)
    s_call_b64 s[66:67], L_issue
    v_add_u32 v6, s46, v5
    ds_read_b64 v[32:33], v7 offset:160
    ds_read_b64_tr_b16 v[48:49], v6 offset:0
    ds_read_b64_tr_b16 v[50:51], v6 offset:1024
    ds_read_b64_tr_b16 v[52:53], v6 offset:2048
    ds_read_b64_tr_b16 v[54:55], v6 offset:3072
    ds_read_b64_tr_b16 v[56:57], v6 offset:256
    ds_read_b64_tr_b16 v[58:59], v6 offset:1280
    ds_read_b64_tr_b16 v[60:61], v6 offset:2304
    ds_read_b64_tr_b16 v[62:63], v6 offset:3328
    s_waitcnt lgkmcnt(8)
    v_cndmask_b32 v36, 0, v32, s[56:57]
    v_cndmask_b32 v37, 0, v33, s[56:57]
    v_cndmask_b32 v38, 0, v32, s[58:59]
    v_cndmask_b32 v39, 0, v33, s[58:59]
    s_waitcnt lgkmcnt(0)
    v_mfma_f32_16x16x16_bf16 v[16:19], v[36:37], v[48:49], v[16:19]
    v_mfma_f32_16x16x16_bf16 v[20:23], v[36:37], v[50:51], v[20:23]
    v_mfma_f32_16x16x16_bf16 v[24:27], v[36:37], v[52:53], v[24:27]
    v_mfma_f32_16x16x16_bf16 v[28:31], v[36:37], v[54:55], v[28:31]
    v_mfma_f32_16x16x16_bf16 v[16:19], v[38:39], v[56:57], v[16:19]
    v_mfma_f32_16x16x16_bf16 v[20:23], v[38:39], v[58:59], v[20:23]
    v_mfma_f32_16x16x16_bf16 v[24:27], v[38:39], v[60:61], v[24:27]
    v_mfma_f32_16x16x16_bf16 v[28:31], v[38:39], v[62:63], v[28:31]
    ds_read_b64_tr_b16 v[48:49], v6 offset:512
    ds_read_b64_tr_b16 v[50:51], v6 offset:1536
    ds_read_b64_tr_b16 v[52:53], v6 offset:2560
    ds_read_b64_tr_b16 v[54:55], v6 offset:3584
    ds_read_b64_tr_b16 v[56:57], v6 offset:768
    ds_read_b64_tr_b16 v[58:59], v6 offset:1792
    ds_read_b64_tr_b16 v[60:61], v6 offset:2816
    ds_read_b64_tr_b16 v[62:63], v6 offset:3840
    v_cndmask_b32 v36, 0, v32, s[60:61]
    v_cndmask_b32 v37, 0, v33, s[60:61]
    v_cndmask_b32 v38, 0, v32, s[62:63]
    v_cndmask_b32 v39, 0, v33, s[62:63]
    s_waitcnt lgkmcnt(0)
    v_mfma_f32_16x16x16_bf16 v[16:19], v[36:37], v[48:49], v[16:19]
    v_mfma_f32_16x16x16_bf16 v[20:23], v[36:37], v[50:51], v[20:23]
    v_mfma_f32_16x16x16_bf16 v[24:27], v[36:37], v[52:53], v[24:27]
    v_mfma_f32_16x16x16_bf16 v[28:31], v[36:37], v[54:55], v[28:31]
    v_mfma_f32_16x16x16_bf16 v[16:19], v[38:39], v[56:57], v[16:19]
    v_mfma_f32_16x16x16_bf16 v[20:23], v[38:39], v[58:59], v[20:23]
    v_mfma_f32_16x16x16_bf16 v[24:27], v[38:39], v[60:61], v[24:27]
    v_mfma_f32_16x16x16_bf16 v[28:31], v[38:39], v[62:63], v[28:31]
    s_add_u32 s46, s46, 8192
    s_cmp_eq_u32 s46, s42
    s_cselect_b32 s46, s41, s46
    s_waitcnt vmcnt(4)
    s_call_b64 s[66:67], L_issue
    s_waitcnt vmcnt(4)
    s_call_b64 s[66:67], L_issue
    v_add_u32 v6, s46, v5
    ds_read_b64 v[32:33], v7 offset:224
    ds_read_b64_tr_b16 v[48:49], v6 offset:0
    ds_read_b64_tr_b16 v[50:51], v6 offset:1024
    ds_read_b64_tr_b16 v[52:53], v6 offset:2048
    ds_read_b64_tr_b16 v[54:55], v6 offset:3072
    ds_read_b64_tr_b16 v[56:57], v6 offset:256
    ds_read_b64_tr_b16 v[58:59], v6 offset:1280
    ds_read_b64_tr_b16 v[60:61], v6 offset:2304
    ds_read_b64_tr_b16 v[62:63], v6 offset:3328
    s_waitcnt lgkmcnt(8)
    v_cndmask_b32 v36, 0, v32, s[56:57]
    v_cndmask_b32 v37, 0, v33, s[56:57]
    v_cndmask_b32 v38, 0, v32, s[58:59]
    v_cndmask_b32 v39, 0, v33, s[58:59]
    s_waitcnt lgkmcnt(0)
    v_mfma_f32_16x16x16_bf16 v[16:19], v[36:37], v[48:49], v[16:19]
    v_mfma_f32_16x16x16_bf16 v[20:23], v[36:37], v[50:51], v[20:23]
    v_mfma_f32_16x16x16_bf16 v[24:27], v[36:37], v[52:53], v[24:27]
    v_mfma_f32_16x16x16_bf16 v[28:31], v[36:37], v[54:55], v[28:31]
    v_mfma_f32_16x16x16_bf16 v[16:19], v[38:39], v[56:57], v[16:19]
    v_mfma_f32_16x16x16_bf16 v[20:23], v[38:39], v[58:59], v[20:23]
    v_mfma_f32_16x16x16_bf16 v[24:27], v[38:39], v[60:61], v[24:27]
    v_mfma_f32_16x16x16_bf16 v[28:31], v[38:39], v[62:63], v[28:31]
    ds_read_b64_tr_b16 v[48:49], v6 offset:512
    ds_read_b64_tr_b16 v[50:51], v6 offset:1536
    ds_read_b64_tr_b16 v[52:53], v6 offset:2560
    ds_read_b64_tr_b16 v[54:55], v6 offset:3584
    ds_read_b64_tr_b16 v[56:57], v6 offset:768
    ds_read_b64_tr_b16 v[58:59], v6 offset:1792
    ds_read_b64_tr_b16 v[60:61], v6 offset:2816
    ds_read_b64_tr_b16 v[62:63], v6 offset:3840
    v_cndmask_b32 v36, 0, v32, s[60:61]
    v_cndmask_b32 v37, 0, v33, s[60:61]
    v_cndmask_b32 v38, 0, v32, s[62:63]
    v_cndmask_b32 v39, 0, v33, s[62:63]
    s_waitcnt lgkmcnt(0)
    v_mfma_f32_16x16x16_bf16 v[16:19], v[36:37], v[48:49], v[16:19]
    v_mfma_f32_16x16x16_bf16 v[20:23], v[36:37], v[50:51], v[20:23]
    v_mfma_f32_16x16x16_bf16 v[24:27], v[36:37], v[52:53], v[24:27]
    v_mfma_f32_16x16x16_bf16 v[28:31], v[36:37], v[54:55], v[28:31]
    v_mfma_f32_16x16x16_bf16 v[16:19], v[38:39], v[56:57], v[16:19]
    v_mfma_f32_16x16x16_bf16 v[20:23], v[38:39], v[58:59], v[20:23]
    v_mfma_f32_16x16x16_bf16 v[24:27], v[38:39], v[60:61], v[24:27]
    v_mfma_f32_16x16x16_bf16 v[28:31], v[38:39], v[62:63], v[28:31]
    s_add_u32 s46, s46, 8192
    s_cmp_eq_u32 s46, s42
    s_cselect_b32 s46, s41, s46
    ds_read2_b64 v[32:35], v7 offset0:0 offset1:4
    s_waitcnt lgkmcnt(0)
    v_cndmask_b32 v36, 0, v32, s[56:57]
    v_cndmask_b32 v37, 0, v33, s[56:57]
    v_cndmask_b32 v38, 0, v34, s[56:57]
    v_cndmask_b32 v39, 0, v35, s[56:57]
    s_nop 1
    v_mfma_f32_16x16x32_bf16 v[16:19], v[36:39], v[64:67], v[16:19]
    v_mfma_f32_16x16x32_bf16 v[20:23], v[36:39], v[80:83], v[20:23]
    v_mfma_f32_16x16x32_bf16 v[24:27], v[36:39], v[96:99], v[24:27]
    v_mfma_f32_16x16x32_bf16 v[28:31], v[36:39], v[112:115], v[28:31]
    v_cndmask_b32 v40, 0, v32, s[58:59]
    v_cndmask_b32 v41, 0, v33, s[58:59]
    v_cndmask_b32 v42, 0, v34, s[58:59]
    v_cndmask_b32 v43, 0, v35, s[58:59]
    s_nop 1
    v_mfma_f32_16x16x32_bf16 v[16:19], v[40:43], v[68:71], v[16:19]
    v_mfma_f32_16x16x32_bf16 v[20:23], v[40:43], v[84:87], v[20:23]
    v_mfma_f32_16x16x32_bf16 v[24:27], v[40:43], v[100:103], v[24:27]
    v_mfma_f32_16x16x32_bf16 v[28:31], v[40:43], v[116:119], v[28:31]
    v_cndmask_b32 v36, 0, v32, s[60:61]
    v_cndmask_b32 v37, 0, v33, s[60:61]
    v_cndmask_b32 v38, 0, v34, s[60:61]
    v_cndmask_b32 v39, 0, v35, s[60:61]
    s_nop 1
    v_mfma_f32_16x16x32_bf16 v[16:19], v[36:39], v[72:75], v[16:19]
    v_mfma_f32_16x16x32_bf16 v[20:23], v[36:39], v[88:91], v[20:23]
    v_mfma_f32_16x16x32_bf16 v[24:27], v[36:39], v[104:107], v[24:27]
    v_mfma_f32_16x16x32_bf16 v[28:31], v[36:39], v[120:123], v[28:31]
    v_cndmask_b32 v40, 0, v32, s[62:63]
    v_cndmask_b32 v41, 0, v33, s[62:63]
    v_cndmask_b32 v42, 0, v34, s[62:63]
    v_cndmask_b32 v43, 0, v35, s[62:63]
    s_nop 1
    v_mfma_f32_16x16x32_bf16 v[16:19], v[40:43], v[76:79], v[16:19]
    v_mfma_f32_16x16x32_bf16 v[20:23], v[40:43], v[92:95], v[20:23]
    v_mfma_f32_16x16x32_bf16 v[24:27], v[40:43], v[108:111], v[24:27]
    v_mfma_f32_16x16x32_bf16 v[28:31], v[40:43], v[124:127], v[28:31]
    s_waitcnt vmcnt(4)
    s_call_b64 s[66:67], L_issue
    s_waitcnt vmcnt(4)
    s_call_b64 s[66:67], L_issue
    v_add_u32 v6, s46, v5
    ds_read_b64 v[32:33], v7 offset:288
    ds_read_b64_tr_b16 v[48:49], v6 offset:0
    ds_read_b64_tr_b16 v[50:51], v6 offset:1024
    ds_read_b64_tr_b16 v[52:53], v6 offset:2048
    ds_read_b64_tr_b16 v[54:55], v6 offset:3072
    ds_read_b64_tr_b16 v[56:57], v6 offset:256
    ds_read_b64_tr_b16 v[58:59], v6 offset:1280
    ds_read_b64_tr_b16 v[60:61], v6 offset:2304
    ds_read_b64_tr_b16 v[62:63], v6 offset:3328
    s_waitcnt lgkmcnt(8)
    v_cndmask_b32 v36, 0, v32, s[56:57]
    v_cndmask_b32 v37, 0, v33, s[56:57]
    v_cndmask_b32 v38, 0, v32, s[58:59]
    v_cndmask_b32 v39, 0, v33, s[58:59]
    s_waitcnt lgkmcnt(0)
    v_mfma_f32_16x16x16_bf16 v[16:19], v[36:37], v[48:49], v[16:19]
    v_mfma_f32_16x16x16_bf16 v[20:23], v[36:37], v[50:51], v[20:23]
    v_mfma_f32_16x16x16_bf16 v[24:27], v[36:37], v[52:53], v[24:27]
    v_mfma_f32_16x16x16_bf16 v[28:31], v[36:37], v[54:55], v[28:31]
    v_mfma_f32_16x16x16_bf16 v[16:19], v[38:39], v[56:57], v[16:19]
    v_mfma_f32_16x16x16_bf16 v[20:23], v[38:39], v[58:59], v[20:23]
    v_mfma_f32_16x16x16_bf16 v[24:27], v[38:39], v[60:61], v[24:27]
    v_mfma_f32_16x16x16_bf16 v[28:31], v[38:39], v[62:63], v[28:31]
    ds_read_b64_tr_b16 v[48:49], v6 offset:512
    ds_read_b64_tr_b16 v[50:51], v6 offset:1536
    ds_read_b64_tr_b16 v[52:53], v6 offset:2560
    ds_read_b64_tr_b16 v[54:55], v6 offset:3584
    ds_read_b64_tr_b16 v[56:57], v6 offset:768
    ds_read_b64_tr_b16 v[58:59], v6 offset:1792
    ds_read_b64_tr_b16 v[60:61], v6 offset:2816
    ds_read_b64_tr_b16 v[62:63], v6 offset:3840
    v_cndmask_b32 v36, 0, v32, s[60:61]
    v_cndmask_b32 v37, 0, v33, s[60:61]
    v_cndmask_b32 v38, 0, v32, s[62:63]
    v_cndmask_b32 v39, 0, v33, s[62:63]
    s_waitcnt lgkmcnt(0)
    v_mfma_f32_16x16x16_bf16 v[16:19], v[36:37], v[48:49], v[16:19]
    v_mfma_f32_16x16x16_bf16 v[20:23], v[36:37], v[50:51], v[20:23]
    v_mfma_f32_16x16x16_bf16 v[24:27], v[36:37], v[52:53], v[24:27]
    v_mfma_f32_16x16x16_bf16 v[28:31], v[36:37], v[54:55], v[28:31]
    v_mfma_f32_16x16x16_bf16 v[16:19], v[38:39], v[56:57], v[16:19]
    v_mfma_f32_16x16x16_bf16 v[20:23], v[38:39], v[58:59], v[20:23]
    v_mfma_f32_16x16x16_bf16 v[24:27], v[38:39], v[60:61], v[24:27]
    v_mfma_f32_16x16x16_bf16 v[28:31], v[38:39], v[62:63], v[28:31]
    s_add_u32 s46, s46, 8192
    s_cmp_eq_u32 s46, s42
    s_cselect_b32 s46, s41, s46
    s_waitcnt vmcnt(4)
    s_call_b64 s[66:67], L_issue
    s_waitcnt vmcnt(4)
    s_call_b64 s[66:67], L_issue
    v_add_u32 v6, s46, v5
    ds_read_b64 v[32:33], v7 offset:352
    ds_read_b64_tr_b16 v[48:49], v6 offset:0
    ds_read_b64_tr_b16 v[50:51], v6 offset:1024
    ds_read_b64_tr_b16 v[52:53], v6 offset:2048
    ds_read_b64_tr_b16 v[54:55], v6 offset:3072
    ds_read_b64_tr_b16 v[56:57], v6 offset:256
    ds_read_b64_tr_b16 v[58:59], v6 offset:1280
    ds_read_b64_tr_b16 v[60:61], v6 offset:2304
    ds_read_b64_tr_b16 v[62:63], v6 offset:3328
    s_waitcnt lgkmcnt(8)
    v_cndmask_b32 v36, 0, v32, s[56:57]
    v_cndmask_b32 v37, 0, v33, s[56:57]
    v_cndmask_b32 v38, 0, v32, s[58:59]
    v_cndmask_b32 v39, 0, v33, s[58:59]
    s_waitcnt lgkmcnt(0)
    v_mfma_f32_16x16x16_bf16 v[16:19], v[36:37], v[48:49], v[16:19]
    v_mfma_f32_16x16x16_bf16 v[20:23], v[36:37], v[50:51], v[20:23]
    v_mfma_f32_16x16x16_bf16 v[24:27], v[36:37], v[52:53], v[24:27]
    v_mfma_f32_16x16x16_bf16 v[28:31], v[36:37], v[54:55], v[28:31]
    v_mfma_f32_16x16x16_bf16 v[16:19], v[38:39], v[56:57], v[16:19]
    v_mfma_f32_16x16x16_bf16 v[20:23], v[38:39], v[58:59], v[20:23]
    v_mfma_f32_16x16x16_bf16 v[24:27], v[38:39], v[60:61], v[24:27]
    v_mfma_f32_16x16x16_bf16 v[28:31], v[38:39], v[62:63], v[28:31]
    ds_read_b64_tr_b16 v[48:49], v6 offset:512
    ds_read_b64_tr_b16 v[50:51], v6 offset:1536
    ds_read_b64_tr_b16 v[52:53], v6 offset:2560
    ds_read_b64_tr_b16 v[54:55], v6 offset:3584
    ds_read_b64_tr_b16 v[56:57], v6 offset:768
    ds_read_b64_tr_b16 v[58:59], v6 offset:1792
    ds_read_b64_tr_b16 v[60:61], v6 offset:2816
    ds_read_b64_tr_b16 v[62:63], v6 offset:3840
    v_cndmask_b32 v36, 0, v32, s[60:61]
    v_cndmask_b32 v37, 0, v33, s[60:61]
    v_cndmask_b32 v38, 0, v32, s[62:63]
    v_cndmask_b32 v39, 0, v33, s[62:63]
    s_waitcnt lgkmcnt(0)
    v_mfma_f32_16x16x16_bf16 v[16:19], v[36:37], v[48:49], v[16:19]
    v_mfma_f32_16x16x16_bf16 v[20:23], v[36:37], v[50:51], v[20:23]
    v_mfma_f32_16x16x16_bf16 v[24:27], v[36:37], v[52:53], v[24:27]
    v_mfma_f32_16x16x16_bf16 v[28:31], v[36:37], v[54:55], v[28:31]
    v_mfma_f32_16x16x16_bf16 v[16:19], v[38:39], v[56:57], v[16:19]
    v_mfma_f32_16x16x16_bf16 v[20:23], v[38:39], v[58:59], v[20:23]
    v_mfma_f32_16x16x16_bf16 v[24:27], v[38:39], v[60:61], v[24:27]
    v_mfma_f32_16x16x16_bf16 v[28:31], v[38:39], v[62:63], v[28:31]
    s_add_u32 s46, s46, 8192
    s_cmp_eq_u32 s46, s42
    s_cselect_b32 s46, s41, s46
    ds_read2_b64 v[32:35], v7 offset0:8 offset1:12
    s_waitcnt lgkmcnt(0)
    v_cndmask_b32 v36, 0, v32, s[56:57]
    v_cndmask_b32 v37, 0, v33, s[56:57]
    v_cndmask_b32 v38, 0, v34, s[56:57]
    v_cndmask_b32 v39, 0, v35, s[56:57]
    s_nop 1
    v_mfma_f32_16x16x32_bf16 v[16:19], v[36:39], v[128:131], v[16:19]
    v_mfma_f32_16x16x32_bf16 v[20:23], v[36:39], v[144:147], v[20:23]
    v_mfma_f32_16x16x32_bf16 v[24:27], v[36:39], v[160:163], v[24:27]
    v_mfma_f32_16x16x32_bf16 v[28:31], v[36:39], v[176:179], v[28:31]
    v_cndmask_b32 v40, 0, v32, s[58:59]
    v_cndmask_b32 v41, 0, v33, s[58:59]
    v_cndmask_b32 v42, 0, v34, s[58:59]
    v_cndmask_b32 v43, 0, v35, s[58:59]
    s_nop 1
    v_mfma_f32_16x16x32_bf16 v[16:19], v[40:43], v[132:135], v[16:19]
    v_mfma_f32_16x16x32_bf16 v[20:23], v[40:43], v[148:151], v[20:23]
    v_mfma_f32_16x16x32_bf16 v[24:27], v[40:43], v[164:167], v[24:27]
    v_mfma_f32_16x16x32_bf16 v[28:31], v[40:43], v[180:183], v[28:31]
    v_cndmask_b32 v36, 0, v32, s[60:61]
    v_cndmask_b32 v37, 0, v33, s[60:61]
    v_cndmask_b32 v38, 0, v34, s[60:61]
    v_cndmask_b32 v39, 0, v35, s[60:61]
    s_nop 1
    v_mfma_f32_16x16x32_bf16 v[16:19], v[36:39], v[136:139], v[16:19]
    v_mfma_f32_16x16x32_bf16 v[20:23], v[36:39], v[152:155], v[20:23]
    v_mfma_f32_16x16x32_bf16 v[24:27], v[36:39], v[168:171], v[24:27]
    v_mfma_f32_16x16x32_bf16 v[28:31], v[36:39], v[184:187], v[28:31]
    v_cndmask_b32 v40, 0, v32, s[62:63]
    v_cndmask_b32 v41, 0, v33, s[62:63]
    v_cndmask_b32 v42, 0, v34, s[62:63]
    v_cndmask_b32 v43, 0, v35, s[62:63]
    s_nop 1
    v_mfma_f32_16x16x32_bf16 v[16:19], v[40:43], v[140:143], v[16:19]
    v_mfma_f32_16x16x32_bf16 v[20:23], v[40:43], v[156:159], v[20:23]
    v_mfma_f32_16x16x32_bf16 v[24:27], v[40:43], v[172:175], v[24:27]
    v_mfma_f32_16x16x32_bf16 v[28:31], v[40:43], v[188:191], v[28:31]
    s_waitcnt vmcnt(4)
    s_call_b64 s[66:67], L_issue
    s_waitcnt vmcnt(4)
    s_call_b64 s[66:67], L_issue
    v_add_u32 v6, s46, v5
    ds_read_b64 v[32:33], v7 offset:416
    ds_read_b64_tr_b16 v[48:49], v6 offset:0
    ds_read_b64_tr_b16 v[50:51], v6 offset:1024
    ds_read_b64_tr_b16 v[52:53], v6 offset:2048
    ds_read_b64_tr_b16 v[54:55], v6 offset:3072
    ds_read_b64_tr_b16 v[56:57], v6 offset:256
    ds_read_b64_tr_b16 v[58:59], v6 offset:1280
    ds_read_b64_tr_b16 v[60:61], v6 offset:2304
    ds_read_b64_tr_b16 v[62:63], v6 offset:3328
    s_waitcnt lgkmcnt(8)
    v_cndmask_b32 v36, 0, v32, s[56:57]
    v_cndmask_b32 v37, 0, v33, s[56:57]
    v_cndmask_b32 v38, 0, v32, s[58:59]
    v_cndmask_b32 v39, 0, v33, s[58:59]
    s_waitcnt lgkmcnt(0)
    v_mfma_f32_16x16x16_bf16 v[16:19], v[36:37], v[48:49], v[16:19]
    v_mfma_f32_16x16x16_bf16 v[20:23], v[36:37], v[50:51], v[20:23]
    v_mfma_f32_16x16x16_bf16 v[24:27], v[36:37], v[52:53], v[24:27]
    v_mfma_f32_16x16x16_bf16 v[28:31], v[36:37], v[54:55], v[28:31]
    v_mfma_f32_16x16x16_bf16 v[16:19], v[38:39], v[56:57], v[16:19]
    v_mfma_f32_16x16x16_bf16 v[20:23], v[38:39], v[58:59], v[20:23]
    v_mfma_f32_16x16x16_bf16 v[24:27], v[38:39], v[60:61], v[24:27]
    v_mfma_f32_16x16x16_bf16 v[28:31], v[38:39], v[62:63], v[28:31]
    ds_read_b64_tr_b16 v[48:49], v6 offset:512
    ds_read_b64_tr_b16 v[50:51], v6 offset:1536
    ds_read_b64_tr_b16 v[52:53], v6 offset:2560
    ds_read_b64_tr_b16 v[54:55], v6 offset:3584
    ds_read_b64_tr_b16 v[56:57], v6 offset:768
    ds_read_b64_tr_b16 v[58:59], v6 offset:1792
    ds_read_b64_tr_b16 v[60:61], v6 offset:2816
    ds_read_b64_tr_b16 v[62:63], v6 offset:3840
    v_cndmask_b32 v36, 0, v32, s[60:61]
    v_cndmask_b32 v37, 0, v33, s[60:61]
    v_cndmask_b32 v38, 0, v32, s[62:63]
    v_cndmask_b32 v39, 0, v33, s[62:63]
    s_waitcnt lgkmcnt(0)
    v_mfma_f32_16x16x16_bf16 v[16:19], v[36:37], v[48:49], v[16:19]
    v_mfma_f32_16x16x16_bf16 v[20:23], v[36:37], v[50:51], v[20:23]
    v_mfma_f32_16x16x16_bf16 v[24:27], v[36:37], v[52:53], v[24:27]
    v_mfma_f32_16x16x16_bf16 v[28:31], v[36:37], v[54:55], v[28:31]
    v_mfma_f32_16x16x16_bf16 v[16:19], v[38:39], v[56:57], v[16:19]
    v_mfma_f32_16x16x16_bf16 v[20:23], v[38:39], v[58:59], v[20:23]
    v_mfma_f32_16x16x16_bf16 v[24:27], v[38:39], v[60:61], v[24:27]
    v_mfma_f32_16x16x16_bf16 v[28:31], v[38:39], v[62:63], v[28:31]
    s_add_u32 s46, s46, 8192
    s_cmp_eq_u32 s46, s42
    s_cselect_b32 s46, s41, s46
    s_waitcnt vmcnt(4)
    s_call_b64 s[66:67], L_issue
    s_waitcnt vmcnt(4)
    s_call_b64 s[66:67], L_issue
    v_add_u32 v6, s46, v5
    ds_read_b64 v[32:33], v7 offset:480
    ds_read_b64_tr_b16 v[48:49], v6 offset:0
    ds_read_b64_tr_b16 v[50:51], v6 offset:1024
    ds_read_b64_tr_b16 v[52:53], v6 offset:2048
    ds_read_b64_tr_b16 v[54:55], v6 offset:3072
    ds_read_b64_tr_b16 v[56:57], v6 offset:256
    ds_read_b64_tr_b16 v[58:59], v6 offset:1280
    ds_read_b64_tr_b16 v[60:61], v6 offset:2304
    ds_read_b64_tr_b16 v[62:63], v6 offset:3328
    s_waitcnt lgkmcnt(8)
    v_cndmask_b32 v36, 0, v32, s[56:57]
    v_cndmask_b32 v37, 0, v33, s[56:57]
    v_cndmask_b32 v38, 0, v32, s[58:59]
    v_cndmask_b32 v39, 0, v33, s[58:59]
    s_waitcnt lgkmcnt(0)
    v_mfma_f32_16x16x16_bf16 v[16:19], v[36:37], v[48:49], v[16:19]
    v_mfma_f32_16x16x16_bf16 v[20:23], v[36:37], v[50:51], v[20:23]
    v_mfma_f32_16x16x16_bf16 v[24:27], v[36:37], v[52:53], v[24:27]
    v_mfma_f32_16x16x16_bf16 v[28:31], v[36:37], v[54:55], v[28:31]
    v_mfma_f32_16x16x16_bf16 v[16:19], v[38:39], v[56:57], v[16:19]
    v_mfma_f32_16x16x16_bf16 v[20:23], v[38:39], v[58:59], v[20:23]
    v_mfma_f32_16x16x16_bf16 v[24:27], v[38:39], v[60:61], v[24:27]
    v_mfma_f32_16x16x16_bf16 v[28:31], v[38:39], v[62:63], v[28:31]
    ds_read_b64_tr_b16 v[48:49], v6 offset:512
    ds_read_b64_tr_b16 v[50:51], v6 offset:1536
    ds_read_b64_tr_b16 v[52:53], v6 offset:2560
    ds_read_b64_tr_b16 v[54:55], v6 offset:3584
    ds_read_b64_tr_b16 v[56:57], v6 offset:768
    ds_read_b64_tr_b16 v[58:59], v6 offset:1792
    ds_read_b64_tr_b16 v[60:61], v6 offset:2816
    ds_read_b64_tr_b16 v[62:63], v6 offset:3840
    v_cndmask_b32 v36, 0, v32, s[60:61]
    v_cndmask_b32 v37, 0, v33, s[60:61]
    v_cndmask_b32 v38, 0, v32, s[62:63]
    v_cndmask_b32 v39, 0, v33, s[62:63]
    s_waitcnt lgkmcnt(0)
    v_mfma_f32_16x16x16_bf16 v[16:19], v[36:37], v[48:49], v[16:19]
    v_mfma_f32_16x16x16_bf16 v[20:23], v[36:37], v[50:51], v[20:23]
    v_mfma_f32_16x16x16_bf16 v[24:27], v[36:37], v[52:53], v[24:27]
    v_mfma_f32_16x16x16_bf16 v[28:31], v[36:37], v[54:55], v[28:31]
    v_mfma_f32_16x16x16_bf16 v[16:19], v[38:39], v[56:57], v[16:19]
    v_mfma_f32_16x16x16_bf16 v[20:23], v[38:39], v[58:59], v[20:23]
    v_mfma_f32_16x16x16_bf16 v[24:27], v[38:39], v[60:61], v[24:27]
    v_mfma_f32_16x16x16_bf16 v[28:31], v[38:39], v[62:63], v[28:31]
    s_add_u32 s46, s46, 8192
    s_cmp_eq_u32 s46, s42
    s_cselect_b32 s46, s41, s46
    s_waitcnt vmcnt(4)
    s_call_b64 s[66:67], L_issue
    s_waitcnt vmcnt(4)
    s_call_b64 s[66:67], L_issue
    v_add_u32 v6, s46, v5
    ds_read_b64 v[32:33], v7 offset:544
    ds_read_b64_tr_b16 v[48:49], v6 offset:0
    ds_read_b64_tr_b16 v[50:51], v6 offset:1024
    ds_read_b64_tr_b16 v[52:53], v6 offset:2048
    ds_read_b64_tr_b16 v[54:55], v6 offset:3072
    ds_read_b64_tr_b16 v[56:57], v6 offset:256
    ds_read_b64_tr_b16 v[58:59], v6 offset:1280
    ds_read_b64_tr_b16 v[60:61], v6 offset:2304
    ds_read_b64_tr_b16 v[62:63], v6 offset:3328
    s_waitcnt lgkmcnt(8)
    v_cndmask_b32 v36, 0, v32, s[56:57]
    v_cndmask_b32 v37, 0, v33, s[56:57]
    v_cndmask_b32 v38, 0, v32, s[58:59]
    v_cndmask_b32 v39, 0, v33, s[58:59]
    s_waitcnt lgkmcnt(0)
    v_mfma_f32_16x16x16_bf16 v[16:19], v[36:37], v[48:49], v[16:19]
    v_mfma_f32_16x16x16_bf16 v[20:23], v[36:37], v[50:51], v[20:23]
    v_mfma_f32_16x16x16_bf16 v[24:27], v[36:37], v[52:53], v[24:27]
    v_mfma_f32_16x16x16_bf16 v[28:31], v[36:37], v[54:55], v[28:31]
    v_mfma_f32_16x16x16_bf16 v[16:19], v[38:39], v[56:57], v[16:19]
    v_mfma_f32_16x16x16_bf16 v[20:23], v[38:39], v[58:59], v[20:23]
    v_mfma_f32_16x16x16_bf16 v[24:27], v[38:39], v[60:61], v[24:27]
    v_mfma_f32_16x16x16_bf16 v[28:31], v[38:39], v[62:63], v[28:31]
    ds_read_b64_tr_b16 v[48:49], v6 offset:512
    ds_read_b64_tr_b16 v[50:51], v6 offset:1536
    ds_read_b64_tr_b16 v[52:53], v6 offset:2560
    ds_read_b64_tr_b16 v[54:55], v6 offset:3584
    ds_read_b64_tr_b16 v[56:57], v6 offset:768
    ds_read_b64_tr_b16 v[58:59], v6 offset:1792
    ds_read_b64_tr_b16 v[60:61], v6 offset:2816
    ds_read_b64_tr_b16 v[62:63], v6 offset:3840
    v_cndmask_b32 v36, 0, v32, s[60:61]
    v_cndmask_b32 v37, 0, v33, s[60:61]
    v_cndmask_b32 v38, 0, v32, s[62:63]
    v_cndmask_b32 v39, 0, v33, s[62:63]
    s_waitcnt lgkmcnt(0)
    v_mfma_f32_16x16x16_bf16 v[16:19], v[36:37], v[48:49], v[16:19]
    v_mfma_f32_16x16x16_bf16 v[20:23], v[36:37], v[50:51], v[20:23]
    v_mfma_f32_16x16x16_bf16 v[24:27], v[36:37], v[52:53], v[24:27]
    v_mfma_f32_16x16x16_bf16 v[28:31], v[36:37], v[54:55], v[28:31]
    v_mfma_f32_16x16x16_bf16 v[16:19], v[38:39], v[56:57], v[16:19]
    v_mfma_f32_16x16x16_bf16 v[20:23], v[38:39], v[58:59], v[20:23]
    v_mfma_f32_16x16x16_bf16 v[24:27], v[38:39], v[60:61], v[24:27]
    v_mfma_f32_16x16x16_bf16 v[28:31], v[38:39], v[62:63], v[28:31]
    s_add_u32 s46, s46, 8192
    s_cmp_eq_u32 s46, s42
    s_cselect_b32 s46, s41, s46
    ds_read2_b64 v[32:35], v7 offset0:16 offset1:24
    s_waitcnt lgkmcnt(0)
    v_cndmask_b32 v36, 0, v32, s[56:57]
    v_cndmask_b32 v37, 0, v33, s[56:57]
    v_cndmask_b32 v38, 0, v34, s[56:57]
    v_cndmask_b32 v39, 0, v35, s[56:57]
    s_nop 1
    v_mfma_f32_16x16x32_bf16 v[16:19], v[36:39], v[192:195], v[16:19]
    v_mfma_f32_16x16x32_bf16 v[20:23], v[36:39], v[208:211], v[20:23]
    v_mfma_f32_16x16x32_bf16 v[24:27], v[36:39], v[224:227], v[24:27]
    v_mfma_f32_16x16x32_bf16 v[28:31], v[36:39], v[240:243], v[28:31]
    v_cndmask_b32 v40, 0, v32, s[58:59]
    v_cndmask_b32 v41, 0, v33, s[58:59]
    v_cndmask_b32 v42, 0, v34, s[58:59]
    v_cndmask_b32 v43, 0, v35, s[58:59]
    s_nop 1
    v_mfma_f32_16x16x32_bf16 v[16:19], v[40:43], v[196:199], v[16:19]
    v_mfma_f32_16x16x32_bf16 v[20:23], v[40:43], v[212:215], v[20:23]
    v_mfma_f32_16x16x32_bf16 v[24:27], v[40:43], v[228:231], v[24:27]
    v_mfma_f32_16x16x32_bf16 v[28:31], v[40:43], v[244:247], v[28:31]
    v_cndmask_b32 v36, 0, v32, s[60:61]
    v_cndmask_b32 v37, 0, v33, s[60:61]
    v_cndmask_b32 v38, 0, v34, s[60:61]
    v_cndmask_b32 v39, 0, v35, s[60:61]
    s_nop 1
    v_mfma_f32_16x16x32_bf16 v[16:19], v[36:39], v[200:203], v[16:19]
    v_mfma_f32_16x16x32_bf16 v[20:23], v[36:39], v[216:219], v[20:23]
    v_mfma_f32_16x16x32_bf16 v[24:27], v[36:39], v[232:235], v[24:27]
    v_mfma_f32_16x16x32_bf16 v[28:31], v[36:39], v[248:251], v[28:31]
    v_cndmask_b32 v40, 0, v32, s[62:63]
    v_cndmask_b32 v41, 0, v33, s[62:63]
    v_cndmask_b32 v42, 0, v34, s[62:63]
    v_cndmask_b32 v43, 0, v35, s[62:63]
    s_nop 1
    v_mfma_f32_16x16x32_bf16 v[16:19], v[40:43], v[204:207], v[16:19]
    v_mfma_f32_16x16x32_bf16 v[20:23], v[40:43], v[220:223], v[20:23]
    v_mfma_f32_16x16x32_bf16 v[24:27], v[40:43], v[236:239], v[24:27]
    v_mfma_f32_16x16x32_bf16 v[28:31], v[40:43], v[252:255], v[28:31]
    s_waitcnt vmcnt(4)
    s_call_b64 s[66:67], L_issue
    s_waitcnt vmcnt(4)
    s_call_b64 s[66:67], L_issue
    v_add_u32 v6, s46, v5
    ds_read_b64 v[32:33], v7 offset:608
    ds_read_b64_tr_b16 v[48:49], v6 offset:0
    ds_read_b64_tr_b16 v[50:51], v6 offset:1024
    ds_read_b64_tr_b16 v[52:53], v6 offset:2048
    ds_read_b64_tr_b16 v[54:55], v6 offset:3072
    ds_read_b64_tr_b16 v[56:57], v6 offset:256
    ds_read_b64_tr_b16 v[58:59], v6 offset:1280
    ds_read_b64_tr_b16 v[60:61], v6 offset:2304
    ds_read_b64_tr_b16 v[62:63], v6 offset:3328
    s_waitcnt lgkmcnt(8)
    v_cndmask_b32 v36, 0, v32, s[56:57]
    v_cndmask_b32 v37, 0, v33, s[56:57]
    v_cndmask_b32 v38, 0, v32, s[58:59]
    v_cndmask_b32 v39, 0, v33, s[58:59]
    s_waitcnt lgkmcnt(0)
    v_mfma_f32_16x16x16_bf16 v[16:19], v[36:37], v[48:49], v[16:19]
    v_mfma_f32_16x16x16_bf16 v[20:23], v[36:37], v[50:51], v[20:23]
    v_mfma_f32_16x16x16_bf16 v[24:27], v[36:37], v[52:53], v[24:27]
    v_mfma_f32_16x16x16_bf16 v[28:31], v[36:37], v[54:55], v[28:31]
    v_mfma_f32_16x16x16_bf16 v[16:19], v[38:39], v[56:57], v[16:19]
    v_mfma_f32_16x16x16_bf16 v[20:23], v[38:39], v[58:59], v[20:23]
    v_mfma_f32_16x16x16_bf16 v[24:27], v[38:39], v[60:61], v[24:27]
    v_mfma_f32_16x16x16_bf16 v[28:31], v[38:39], v[62:63], v[28:31]
    ds_read_b64_tr_b16 v[48:49], v6 offset:512
    ds_read_b64_tr_b16 v[50:51], v6 offset:1536
    ds_read_b64_tr_b16 v[52:53], v6 offset:2560
    ds_read_b64_tr_b16 v[54:55], v6 offset:3584
    ds_read_b64_tr_b16 v[56:57], v6 offset:768
    ds_read_b64_tr_b16 v[58:59], v6 offset:1792
    ds_read_b64_tr_b16 v[60:61], v6 offset:2816
    ds_read_b64_tr_b16 v[62:63], v6 offset:3840
    v_cndmask_b32 v36, 0, v32, s[60:61]
    v_cndmask_b32 v37, 0, v33, s[60:61]
    v_cndmask_b32 v38, 0, v32, s[62:63]
    v_cndmask_b32 v39, 0, v33, s[62:63]
    s_waitcnt lgkmcnt(0)
    v_mfma_f32_16x16x16_bf16 v[16:19], v[36:37], v[48:49], v[16:19]
    v_mfma_f32_16x16x16_bf16 v[20:23], v[36:37], v[50:51], v[20:23]
    v_mfma_f32_16x16x16_bf16 v[24:27], v[36:37], v[52:53], v[24:27]
    v_mfma_f32_16x16x16_bf16 v[28:31], v[36:37], v[54:55], v[28:31]
    v_mfma_f32_16x16x16_bf16 v[16:19], v[38:39], v[56:57], v[16:19]
    v_mfma_f32_16x16x16_bf16 v[20:23], v[38:39], v[58:59], v[20:23]
    v_mfma_f32_16x16x16_bf16 v[24:27], v[38:39], v[60:61], v[24:27]
    v_mfma_f32_16x16x16_bf16 v[28:31], v[38:39], v[62:63], v[28:31]
    s_add_u32 s46, s46, 8192
    s_cmp_eq_u32 s46, s42
    s_cselect_b32 s46, s41, s46
    s_waitcnt vmcnt(4)
    s_call_b64 s[66:67], L_issue
    s_waitcnt vmcnt(4)
    s_call_b64 s[66:67], L_issue
    v_add_u32 v6, s46, v5
    ds_read_b64 v[32:33], v7 offset:672
    ds_read_b64_tr_b16 v[48:49], v6 offset:0
    ds_read_b64_tr_b16 v[50:51], v6 offset:1024
    ds_read_b64_tr_b16 v[52:53], v6 offset:2048
    ds_read_b64_tr_b16 v[54:55], v6 offset:3072
    ds_read_b64_tr_b16 v[56:57], v6 offset:256
    ds_read_b64_tr_b16 v[58:59], v6 offset:1280
    ds_read_b64_tr_b16 v[60:61], v6 offset:2304
    ds_read_b64_tr_b16 v[62:63], v6 offset:3328
    s_waitcnt lgkmcnt(8)
    v_cndmask_b32 v36, 0, v32, s[56:57]
    v_cndmask_b32 v37, 0, v33, s[56:57]
    v_cndmask_b32 v38, 0, v32, s[58:59]
    v_cndmask_b32 v39, 0, v33, s[58:59]
    s_waitcnt lgkmcnt(0)
    v_mfma_f32_16x16x16_bf16 v[16:19], v[36:37], v[48:49], v[16:19]
    v_mfma_f32_16x16x16_bf16 v[20:23], v[36:37], v[50:51], v[20:23]
    v_mfma_f32_16x16x16_bf16 v[24:27], v[36:37], v[52:53], v[24:27]
    v_mfma_f32_16x16x16_bf16 v[28:31], v[36:37], v[54:55], v[28:31]
    v_mfma_f32_16x16x16_bf16 v[16:19], v[38:39], v[56:57], v[16:19]
    v_mfma_f32_16x16x16_bf16 v[20:23], v[38:39], v[58:59], v[20:23]
    v_mfma_f32_16x16x16_bf16 v[24:27], v[38:39], v[60:61], v[24:27]
    v_mfma_f32_16x16x16_bf16 v[28:31], v[38:39], v[62:63], v[28:31]
    ds_read_b64_tr_b16 v[48:49], v6 offset:512
    ds_read_b64_tr_b16 v[50:51], v6 offset:1536
    ds_read_b64_tr_b16 v[52:53], v6 offset:2560
    ds_read_b64_tr_b16 v[54:55], v6 offset:3584
    ds_read_b64_tr_b16 v[56:57], v6 offset:768
    ds_read_b64_tr_b16 v[58:59], v6 offset:1792
    ds_read_b64_tr_b16 v[60:61], v6 offset:2816
    ds_read_b64_tr_b16 v[62:63], v6 offset:3840
    v_cndmask_b32 v36, 0, v32, s[60:61]
    v_cndmask_b32 v37, 0, v33, s[60:61]
    v_cndmask_b32 v38, 0, v32, s[62:63]
    v_cndmask_b32 v39, 0, v33, s[62:63]
    s_waitcnt lgkmcnt(0)
    v_mfma_f32_16x16x16_bf16 v[16:19], v[36:37], v[48:49], v[16:19]
    v_mfma_f32_16x16x16_bf16 v[20:23], v[36:37], v[50:51], v[20:23]
    v_mfma_f32_16x16x16_bf16 v[24:27], v[36:37], v[52:53], v[24:27]
    v_mfma_f32_16x16x16_bf16 v[28:31], v[36:37], v[54:55], v[28:31]
    v_mfma_f32_16x16x16_bf16 v[16:19], v[38:39], v[56:57], v[16:19]
    v_mfma_f32_16x16x16_bf16 v[20:23], v[38:39], v[58:59], v[20:23]
    v_mfma_f32_16x16x16_bf16 v[24:27], v[38:39], v[60:61], v[24:27]
    v_mfma_f32_16x16x16_bf16 v[28:31], v[38:39], v[62:63], v[28:31]
    s_add_u32 s46, s46, 8192
    s_cmp_eq_u32 s46, s42
    s_cselect_b32 s46, s41, s46
    ds_read2_b64 v[32:35], v7 offset0:32 offset1:40
    s_waitcnt lgkmcnt(0)
    v_cndmask_b32 v36, 0, v32, s[56:57]
    v_cndmask_b32 v37, 0, v33, s[56:57]
    v_cndmask_b32 v38, 0, v34, s[56:57]
    v_cndmask_b32 v39, 0, v35, s[56:57]
    s_nop 1
    v_mfma_f32_16x16x32_bf16 v[16:19], v[36:39], a[0:3], v[16:19]
    v_mfma_f32_16x16x32_bf16 v[20:23], v[36:39], a[16:19], v[20:23]
    v_mfma_f32_16x16x32_bf16 v[24:27], v[36:39], a[32:35], v[24:27]
    v_mfma_f32_16x16x32_bf16 v[28:31], v[36:39], a[48:51], v[28:31]
    v_cndmask_b32 v40, 0, v32, s[58:59]
    v_cndmask_b32 v41, 0, v33, s[58:59]
    v_cndmask_b32 v42, 0, v34, s[58:59]
    v_cndmask_b32 v43, 0, v35, s[58:59]
    s_nop 1
    v_mfma_f32_16x16x32_bf16 v[16:19], v[40:43], a[4:7], v[16:19]
    v_mfma_f32_16x16x32_bf16 v[20:23], v[40:43], a[20:23], v[20:23]
    v_mfma_f32_16x16x32_bf16 v[24:27], v[40:43], a[36:39], v[24:27]
    v_mfma_f32_16x16x32_bf16 v[28:31], v[40:43], a[52:55], v[28:31]
    v_cndmask_b32 v36, 0, v32, s[60:61]
    v_cndmask_b32 v37, 0, v33, s[60:61]
    v_cndmask_b32 v38, 0, v34, s[60:61]
    v_cndmask_b32 v39, 0, v35, s[60:61]
    s_nop 1
    v_mfma_f32_16x16x32_bf16 v[16:19], v[36:39], a[8:11], v[16:19]
    v_mfma_f32_16x16x32_bf16 v[20:23], v[36:39], a[24:27], v[20:23]
    v_mfma_f32_16x16x32_bf16 v[24:27], v[36:39], a[40:43], v[24:27]
    v_mfma_f32_16x16x32_bf16 v[28:31], v[36:39], a[56:59], v[28:31]
    v_cndmask_b32 v40, 0, v32, s[62:63]
    v_cndmask_b32 v41, 0, v33, s[62:63]
    v_cndmask_b32 v42, 0, v34, s[62:63]
    v_cndmask_b32 v43, 0, v35, s[62:63]
    s_nop 1
    v_mfma_f32_16x16x32_bf16 v[16:19], v[40:43], a[12:15], v[16:19]
    v_mfma_f32_16x16x32_bf16 v[20:23], v[40:43], a[28:31], v[20:23]
    v_mfma_f32_16x16x32_bf16 v[24:27], v[40:43], a[44:47], v[24:27]
    v_mfma_f32_16x16x32_bf16 v[28:31], v[40:43], a[60:63], v[28:31]
    s_waitcnt vmcnt(4)
    s_call_b64 s[66:67], L_issue
    v_min_u32 v47, L_endcode-L_gapcode-4, v46
    global_load_dword v47, v47, s[18:19]
    v_add_u32 v46, 8192, v46
    s_waitcnt vmcnt(5)
    s_call_b64 s[66:67], L_issue
    v_add_u32 v6, s46, v5
    ds_read_b64 v[32:33], v7 offset:736
    ds_read_b64_tr_b16 v[48:49], v6 offset:0
    ds_read_b64_tr_b16 v[50:51], v6 offset:1024
    ds_read_b64_tr_b16 v[52:53], v6 offset:2048
    ds_read_b64_tr_b16 v[54:55], v6 offset:3072
    ds_read_b64_tr_b16 v[56:57], v6 offset:256
    ds_read_b64_tr_b16 v[58:59], v6 offset:1280
    ds_read_b64_tr_b16 v[60:61], v6 offset:2304
    ds_read_b64_tr_b16 v[62:63], v6 offset:3328
    s_waitcnt lgkmcnt(8)
    v_cndmask_b32 v36, 0, v32, s[56:57]
    v_cndmask_b32 v37, 0, v33, s[56:57]
    v_cndmask_b32 v38, 0, v32, s[58:59]
    v_cndmask_b32 v39, 0, v33, s[58:59]
    s_waitcnt lgkmcnt(0)
    v_mfma_f32_16x16x16_bf16 v[16:19], v[36:37], v[48:49], v[16:19]
    v_mfma_f32_16x16x16_bf16 v[20:23], v[36:37], v[50:51], v[20:23]
    v_mfma_f32_16x16x16_bf16 v[24:27], v[36:37], v[52:53], v[24:27]
    v_mfma_f32_16x16x16_bf16 v[28:31], v[36:37], v[54:55], v[28:31]
    v_mfma_f32_16x16x16_bf16 v[16:19], v[38:39], v[56:57], v[16:19]
    v_mfma_f32_16x16x16_bf16 v[20:23], v[38:39], v[58:59], v[20:23]
    v_mfma_f32_16x16x16_bf16 v[24:27], v[38:39], v[60:61], v[24:27]
    v_mfma_f32_16x16x16_bf16 v[28:31], v[38:39], v[62:63], v[28:31]
    ds_read_b64_tr_b16 v[48:49], v6 offset:512
    ds_read_b64_tr_b16 v[50:51], v6 offset:1536
    ds_read_b64_tr_b16 v[52:53], v6 offset:2560
    ds_read_b64_tr_b16 v[54:55], v6 offset:3584
    ds_read_b64_tr_b16 v[56:57], v6 offset:768
    ds_read_b64_tr_b16 v[58:59], v6 offset:1792
    ds_read_b64_tr_b16 v[60:61], v6 offset:2816
    ds_read_b64_tr_b16 v[62:63], v6 offset:3840
    v_cndmask_b32 v36, 0, v32, s[60:61]
    v_cndmask_b32 v37, 0, v33, s[60:61]
    v_cndmask_b32 v38, 0, v32, s[62:63]
    v_cndmask_b32 v39, 0, v33, s[62:63]
    s_waitcnt lgkmcnt(0)
    v_mfma_f32_16x16x16_bf16 v[16:19], v[36:37], v[48:49], v[16:19]
    v_mfma_f32_16x16x16_bf16 v[20:23], v[36:37], v[50:51], v[20:23]
    v_mfma_f32_16x16x16_bf16 v[24:27], v[36:37], v[52:53], v[24:27]
    v_mfma_f32_16x16x16_bf16 v[28:31], v[36:37], v[54:55], v[28:31]
    v_mfma_f32_16x16x16_bf16 v[16:19], v[38:39], v[56:57], v[16:19]
    v_mfma_f32_16x16x16_bf16 v[20:23], v[38:39], v[58:59], v[20:23]
    v_mfma_f32_16x16x16_bf16 v[24:27], v[38:39], v[60:61], v[24:27]
    v_mfma_f32_16x16x16_bf16 v[28:31], v[38:39], v[62:63], v[28:31]
    s_add_u32 s46, s46, 8192
    s_cmp_eq_u32 s46, s42
    s_cselect_b32 s46, s41, s46
    s_waitcnt vmcnt(4)
    s_call_b64 s[66:67], L_issue
    s_waitcnt vmcnt(4)
    s_call_b64 s[66:67], L_issue
    v_add_u32 v6, s46, v5
    ds_read_b64 v[32:33], v7 offset:768
    ds_read_b64_tr_b16 v[48:49], v6 offset:0
    ds_read_b64_tr_b16 v[50:51], v6 offset:1024
    ds_read_b64_tr_b16 v[52:53], v6 offset:2048
    ds_read_b64_tr_b16 v[54:55], v6 offset:3072
    ds_read_b64_tr_b16 v[56:57], v6 offset:256
    ds_read_b64_tr_b16 v[58:59], v6 offset:1280
    ds_read_b64_tr_b16 v[60:61], v6 offset:2304
    ds_read_b64_tr_b16 v[62:63], v6 offset:3328
    s_waitcnt lgkmcnt(8)
    v_cndmask_b32 v36, 0, v32, s[56:57]
    v_cndmask_b32 v37, 0, v33, s[56:57]
    v_cndmask_b32 v38, 0, v32, s[58:59]
    v_cndmask_b32 v39, 0, v33, s[58:59]
    s_waitcnt lgkmcnt(0)
    v_mfma_f32_16x16x16_bf16 v[16:19], v[36:37], v[48:49], v[16:19]
    v_mfma_f32_16x16x16_bf16 v[20:23], v[36:37], v[50:51], v[20:23]
    v_mfma_f32_16x16x16_bf16 v[24:27], v[36:37], v[52:53], v[24:27]
    v_mfma_f32_16x16x16_bf16 v[28:31], v[36:37], v[54:55], v[28:31]
    v_mfma_f32_16x16x16_bf16 v[16:19], v[38:39], v[56:57], v[16:19]
    v_mfma_f32_16x16x16_bf16 v[20:23], v[38:39], v[58:59], v[20:23]
    v_mfma_f32_16x16x16_bf16 v[24:27], v[38:39], v[60:61], v[24:27]
    v_mfma_f32_16x16x16_bf16 v[28:31], v[38:39], v[62:63], v[28:31]
    ds_read_b64_tr_b16 v[48:49], v6 offset:512
    ds_read_b64_tr_b16 v[50:51], v6 offset:1536
    ds_read_b64_tr_b16 v[52:53], v6 offset:2560
    ds_read_b64_tr_b16 v[54:55], v6 offset:3584
    ds_read_b64_tr_b16 v[56:57], v6 offset:768
    ds_read_b64_tr_b16 v[58:59], v6 offset:1792
    ds_read_b64_tr_b16 v[60:61], v6 offset:2816
    ds_read_b64_tr_b16 v[62:63], v6 offset:3840
    v_cndmask_b32 v36, 0, v32, s[60:61]
    v_cndmask_b32 v37, 0, v33, s[60:61]
    v_cndmask_b32 v38, 0, v32, s[62:63]
    v_cndmask_b32 v39, 0, v33, s[62:63]
    s_waitcnt lgkmcnt(0)
    v_mfma_f32_16x16x16_bf16 v[16:19], v[36:37], v[48:49], v[16:19]
    v_mfma_f32_16x16x16_bf16 v[20:23], v[36:37], v[50:51], v[20:23]
    v_mfma_f32_16x16x16_bf16 v[24:27], v[36:37], v[52:53], v[24:27]
    v_mfma_f32_16x16x16_bf16 v[28:31], v[36:37], v[54:55], v[28:31]
    v_mfma_f32_16x16x16_bf16 v[16:19], v[38:39], v[56:57], v[16:19]
    v_mfma_f32_16x16x16_bf16 v[20:23], v[38:39], v[58:59], v[20:23]
    v_mfma_f32_16x16x16_bf16 v[24:27], v[38:39], v[60:61], v[24:27]
    v_mfma_f32_16x16x16_bf16 v[28:31], v[38:39], v[62:63], v[28:31]
    s_add_u32 s46, s46, 8192
    s_cmp_eq_u32 s46, s42
    s_cselect_b32 s46, s41, s46
    s_waitcnt vmcnt(4)
    s_call_b64 s[66:67], L_issue
    v_min_u32 v47, L_endcode-L_gapcode-4, v46
    global_load_dword v47, v47, s[18:19]
    v_add_u32 v46, 8192, v46
    s_waitcnt vmcnt(5)
    s_call_b64 s[66:67], L_issue
    v_add_u32 v6, s46, v5
    ds_read_b64 v[32:33], v7 offset:800
    ds_read_b64_tr_b16 v[48:49], v6 offset:0
    ds_read_b64_tr_b16 v[50:51], v6 offset:1024
    ds_read_b64_tr_b16 v[52:53], v6 offset:2048
    ds_read_b64_tr_b16 v[54:55], v6 offset:3072
    ds_read_b64_tr_b16 v[56:57], v6 offset:256
    ds_read_b64_tr_b16 v[58:59], v6 offset:1280
    ds_read_b64_tr_b16 v[60:61], v6 offset:2304
    ds_read_b64_tr_b16 v[62:63], v6 offset:3328
    s_waitcnt lgkmcnt(8)
    v_cndmask_b32 v36, 0, v32, s[56:57]
    v_cndmask_b32 v37, 0, v33, s[56:57]
    v_cndmask_b32 v38, 0, v32, s[58:59]
    v_cndmask_b32 v39, 0, v33, s[58:59]
    s_waitcnt lgkmcnt(0)
    v_mfma_f32_16x16x16_bf16 v[16:19], v[36:37], v[48:49], v[16:19]
    v_mfma_f32_16x16x16_bf16 v[20:23], v[36:37], v[50:51], v[20:23]
    v_mfma_f32_16x16x16_bf16 v[24:27], v[36:37], v[52:53], v[24:27]
    v_mfma_f32_16x16x16_bf16 v[28:31], v[36:37], v[54:55], v[28:31]
    v_mfma_f32_16x16x16_bf16 v[16:19], v[38:39], v[56:57], v[16:19]
    v_mfma_f32_16x16x16_bf16 v[20:23], v[38:39], v[58:59], v[20:23]
    v_mfma_f32_16x16x16_bf16 v[24:27], v[38:39], v[60:61], v[24:27]
    v_mfma_f32_16x16x16_bf16 v[28:31], v[38:39], v[62:63], v[28:31]
    ds_read_b64_tr_b16 v[48:49], v6 offset:512
    ds_read_b64_tr_b16 v[50:51], v6 offset:1536
    ds_read_b64_tr_b16 v[52:53], v6 offset:2560
    ds_read_b64_tr_b16 v[54:55], v6 offset:3584
    ds_read_b64_tr_b16 v[56:57], v6 offset:768
    ds_read_b64_tr_b16 v[58:59], v6 offset:1792
    ds_read_b64_tr_b16 v[60:61], v6 offset:2816
    ds_read_b64_tr_b16 v[62:63], v6 offset:3840
    v_cndmask_b32 v36, 0, v32, s[60:61]
    v_cndmask_b32 v37, 0, v33, s[60:61]
    v_cndmask_b32 v38, 0, v32, s[62:63]
    v_cndmask_b32 v39, 0, v33, s[62:63]
    s_waitcnt lgkmcnt(0)
    v_mfma_f32_16x16x16_bf16 v[16:19], v[36:37], v[48:49], v[16:19]
    v_mfma_f32_16x16x16_bf16 v[20:23], v[36:37], v[50:51], v[20:23]
    v_mfma_f32_16x16x16_bf16 v[24:27], v[36:37], v[52:53], v[24:27]
    v_mfma_f32_16x16x16_bf16 v[28:31], v[36:37], v[54:55], v[28:31]
    v_mfma_f32_16x16x16_bf16 v[16:19], v[38:39], v[56:57], v[16:19]
    v_mfma_f32_16x16x16_bf16 v[20:23], v[38:39], v[58:59], v[20:23]
    v_mfma_f32_16x16x16_bf16 v[24:27], v[38:39], v[60:61], v[24:27]
    v_mfma_f32_16x16x16_bf16 v[28:31], v[38:39], v[62:63], v[28:31]
    s_add_u32 s46, s46, 8192
    s_cmp_eq_u32 s46, s42
    s_cselect_b32 s46, s41, s46
    ds_read2_b64 v[32:35], v7 offset0:48 offset1:56
    s_waitcnt lgkmcnt(0)
    v_cndmask_b32 v36, 0, v32, s[56:57]
    v_cndmask_b32 v37, 0, v33, s[56:57]
    v_cndmask_b32 v38, 0, v34, s[56:57]
    v_cndmask_b32 v39, 0, v35, s[56:57]
    s_nop 1
    v_mfma_f32_16x16x32_bf16 v[16:19], v[36:39], a[64:67], v[16:19]
    v_mfma_f32_16x16x32_bf16 v[20:23], v[36:39], a[80:83], v[20:23]
    v_mfma_f32_16x16x32_bf16 v[24:27], v[36:39], a[96:99], v[24:27]
    v_mfma_f32_16x16x32_bf16 v[28:31], v[36:39], a[112:115], v[28:31]
    v_cndmask_b32 v40, 0, v32, s[58:59]
    v_cndmask_b32 v41, 0, v33, s[58:59]
    v_cndmask_b32 v42, 0, v34, s[58:59]
    v_cndmask_b32 v43, 0, v35, s[58:59]
    s_nop 1
    v_mfma_f32_16x16x32_bf16 v[16:19], v[40:43], a[68:71], v[16:19]
    v_mfma_f32_16x16x32_bf16 v[20:23], v[40:43], a[84:87], v[20:23]
    v_mfma_f32_16x16x32_bf16 v[24:27], v[40:43], a[100:103], v[24:27]
    v_mfma_f32_16x16x32_bf16 v[28:31], v[40:43], a[116:119], v[28:31]
    v_cndmask_b32 v36, 0, v32, s[60:61]
    v_cndmask_b32 v37, 0, v33, s[60:61]
    v_cndmask_b32 v38, 0, v34, s[60:61]
    v_cndmask_b32 v39, 0, v35, s[60:61]
    s_nop 1
    v_mfma_f32_16x16x32_bf16 v[16:19], v[36:39], a[72:75], v[16:19]
    v_mfma_f32_16x16x32_bf16 v[20:23], v[36:39], a[88:91], v[20:23]
    v_mfma_f32_16x16x32_bf16 v[24:27], v[36:39], a[104:107], v[24:27]
    v_mfma_f32_16x16x32_bf16 v[28:31], v[36:39], a[120:123], v[28:31]
    v_cndmask_b32 v40, 0, v32, s[62:63]
    v_cndmask_b32 v41, 0, v33, s[62:63]
    v_cndmask_b32 v42, 0, v34, s[62:63]
    v_cndmask_b32 v43, 0, v35, s[62:63]
    s_nop 1
    v_mfma_f32_16x16x32_bf16 v[16:19], v[40:43], a[76:79], v[16:19]
    v_mfma_f32_16x16x32_bf16 v[20:23], v[40:43], a[92:95], v[20:23]
    v_mfma_f32_16x16x32_bf16 v[24:27], v[40:43], a[108:111], v[24:27]
    v_mfma_f32_16x16x32_bf16 v[28:31], v[40:43], a[124:127], v[28:31]
    s_waitcnt vmcnt(4)
    s_call_b64 s[66:67], L_issue
    s_waitcnt vmcnt(4)
    s_call_b64 s[66:67], L_issue
    v_add_u32 v6, s46, v5
    ds_read_b64 v[32:33], v7 offset:832
    ds_read_b64_tr_b16 v[48:49], v6 offset:0
    ds_read_b64_tr_b16 v[50:51], v6 offset:1024
    ds_read_b64_tr_b16 v[52:53], v6 offset:2048
    ds_read_b64_tr_b16 v[54:55], v6 offset:3072
    ds_read_b64_tr_b16 v[56:57], v6 offset:256
    ds_read_b64_tr_b16 v[58:59], v6 offset:1280
    ds_read_b64_tr_b16 v[60:61], v6 offset:2304
    ds_read_b64_tr_b16 v[62:63], v6 offset:3328
    s_waitcnt lgkmcnt(8)
    v_cndmask_b32 v36, 0, v32, s[56:57]
    v_cndmask_b32 v37, 0, v33, s[56:57]
    v_cndmask_b32 v38, 0, v32, s[58:59]
    v_cndmask_b32 v39, 0, v33, s[58:59]
    s_waitcnt lgkmcnt(0)
    v_mfma_f32_16x16x16_bf16 v[16:19], v[36:37], v[48:49], v[16:19]
    v_mfma_f32_16x16x16_bf16 v[20:23], v[36:37], v[50:51], v[20:23]
    v_mfma_f32_16x16x16_bf16 v[24:27], v[36:37], v[52:53], v[24:27]
    v_mfma_f32_16x16x16_bf16 v[28:31], v[36:37], v[54:55], v[28:31]
    v_mfma_f32_16x16x16_bf16 v[16:19], v[38:39], v[56:57], v[16:19]
    v_mfma_f32_16x16x16_bf16 v[20:23], v[38:39], v[58:59], v[20:23]
    v_mfma_f32_16x16x16_bf16 v[24:27], v[38:39], v[60:61], v[24:27]
    v_mfma_f32_16x16x16_bf16 v[28:31], v[38:39], v[62:63], v[28:31]
    ds_read_b64_tr_b16 v[48:49], v6 offset:512
    ds_read_b64_tr_b16 v[50:51], v6 offset:1536
    ds_read_b64_tr_b16 v[52:53], v6 offset:2560
    ds_read_b64_tr_b16 v[54:55], v6 offset:3584
    ds_read_b64_tr_b16 v[56:57], v6 offset:768
    ds_read_b64_tr_b16 v[58:59], v6 offset:1792
    ds_read_b64_tr_b16 v[60:61], v6 offset:2816
    ds_read_b64_tr_b16 v[62:63], v6 offset:3840
    v_cndmask_b32 v36, 0, v32, s[60:61]
    v_cndmask_b32 v37, 0, v33, s[60:61]
    v_cndmask_b32 v38, 0, v32, s[62:63]
    v_cndmask_b32 v39, 0, v33, s[62:63]
    s_waitcnt lgkmcnt(0)
    v_mfma_f32_16x16x16_bf16 v[16:19], v[36:37], v[48:49], v[16:19]
    v_mfma_f32_16x16x16_bf16 v[20:23], v[36:37], v[50:51], v[20:23]
    v_mfma_f32_16x16x16_bf16 v[24:27], v[36:37], v[52:53], v[24:27]
    v_mfma_f32_16x16x16_bf16 v[28:31], v[36:37], v[54:55], v[28:31]
    v_mfma_f32_16x16x16_bf16 v[16:19], v[38:39], v[56:57], v[16:19]
    v_mfma_f32_16x16x16_bf16 v[20:23], v[38:39], v[58:59], v[20:23]
    v_mfma_f32_16x16x16_bf16 v[24:27], v[38:39], v[60:61], v[24:27]
    v_mfma_f32_16x16x16_bf16 v[28:31], v[38:39], v[62:63], v[28:31]
    s_add_u32 s46, s46, 8192
    s_cmp_eq_u32 s46, s42
    s_cselect_b32 s46, s41, s46
    s_waitcnt vmcnt(4)
    s_call_b64 s[66:67], L_issue
    s_waitcnt vmcnt(4)
    s_call_b64 s[66:67], L_issue
    v_add_u32 v6, s46, v5
    ds_read_b64 v[32:33], v7 offset:864
    ds_read_b64_tr_b16 v[48:49], v6 offset:0
    ds_read_b64_tr_b16 v[50:51], v6 offset:1024
    ds_read_b64_tr_b16 v[52:53], v6 offset:2048
    ds_read_b64_tr_b16 v[54:55], v6 offset:3072
    ds_read_b64_tr_b16 v[56:57], v6 offset:256
    ds_read_b64_tr_b16 v[58:59], v6 offset:1280
    ds_read_b64_tr_b16 v[60:61], v6 offset:2304
    ds_read_b64_tr_b16 v[62:63], v6 offset:3328
    s_waitcnt lgkmcnt(8)
    v_cndmask_b32 v36, 0, v32, s[56:57]
    v_cndmask_b32 v37, 0, v33, s[56:57]
    v_cndmask_b32 v38, 0, v32, s[58:59]
    v_cndmask_b32 v39, 0, v33, s[58:59]
    s_waitcnt lgkmcnt(0)
    v_mfma_f32_16x16x16_bf16 v[16:19], v[36:37], v[48:49], v[16:19]
    v_mfma_f32_16x16x16_bf16 v[20:23], v[36:37], v[50:51], v[20:23]
    v_mfma_f32_16x16x16_bf16 v[24:27], v[36:37], v[52:53], v[24:27]
    v_mfma_f32_16x16x16_bf16 v[28:31], v[36:37], v[54:55], v[28:31]
    v_mfma_f32_16x16x16_bf16 v[16:19], v[38:39], v[56:57], v[16:19]
    v_mfma_f32_16x16x16_bf16 v[20:23], v[38:39], v[58:59], v[20:23]
    v_mfma_f32_16x16x16_bf16 v[24:27], v[38:39], v[60:61], v[24:27]
    v_mfma_f32_16x16x16_bf16 v[28:31], v[38:39], v[62:63], v[28:31]
    ds_read_b64_tr_b16 v[48:49], v6 offset:512
    ds_read_b64_tr_b16 v[50:51], v6 offset:1536
    ds_read_b64_tr_b16 v[52:53], v6 offset:2560
    ds_read_b64_tr_b16 v[54:55], v6 offset:3584
    ds_read_b64_tr_b16 v[56:57], v6 offset:768
    ds_read_b64_tr_b16 v[58:59], v6 offset:1792
    ds_read_b64_tr_b16 v[60:61], v6 offset:2816
    ds_read_b64_tr_b16 v[62:63], v6 offset:3840
    v_cndmask_b32 v36, 0, v32, s[60:61]
    v_cndmask_b32 v37, 0, v33, s[60:61]
    v_cndmask_b32 v38, 0, v32, s[62:63]
    v_cndmask_b32 v39, 0, v33, s[62:63]
    s_waitcnt lgkmcnt(0)
    v_mfma_f32_16x16x16_bf16 v[16:19], v[36:37], v[48:49], v[16:19]
    v_mfma_f32_16x16x16_bf16 v[20:23], v[36:37], v[50:51], v[20:23]
    v_mfma_f32_16x16x16_bf16 v[24:27], v[36:37], v[52:53], v[24:27]
    v_mfma_f32_16x16x16_bf16 v[28:31], v[36:37], v[54:55], v[28:31]
    v_mfma_f32_16x16x16_bf16 v[16:19], v[38:39], v[56:57], v[16:19]
    v_mfma_f32_16x16x16_bf16 v[20:23], v[38:39], v[58:59], v[20:23]
    v_mfma_f32_16x16x16_bf16 v[24:27], v[38:39], v[60:61], v[24:27]
    v_mfma_f32_16x16x16_bf16 v[28:31], v[38:39], v[62:63], v[28:31]
    s_add_u32 s46, s46, 8192
    s_cmp_eq_u32 s46, s42
    s_cselect_b32 s46, s41, s46
    ds_read2_b64 v[32:35], v7 offset0:64 offset1:72
    s_waitcnt lgkmcnt(0)
    v_cndmask_b32 v36, 0, v32, s[56:57]
    v_cndmask_b32 v37, 0, v33, s[56:57]
    v_cndmask_b32 v38, 0, v34, s[56:57]
    v_cndmask_b32 v39, 0, v35, s[56:57]
    s_nop 1
    v_mfma_f32_16x16x32_bf16 v[16:19], v[36:39], a[128:131], v[16:19]
    v_mfma_f32_16x16x32_bf16 v[20:23], v[36:39], a[144:147], v[20:23]
    v_mfma_f32_16x16x32_bf16 v[24:27], v[36:39], a[160:163], v[24:27]
    v_mfma_f32_16x16x32_bf16 v[28:31], v[36:39], a[176:179], v[28:31]
    v_cndmask_b32 v40, 0, v32, s[58:59]
    v_cndmask_b32 v41, 0, v33, s[58:59]
    v_cndmask_b32 v42, 0, v34, s[58:59]
    v_cndmask_b32 v43, 0, v35, s[58:59]
    s_nop 1
    v_mfma_f32_16x16x32_bf16 v[16:19], v[40:43], a[132:135], v[16:19]
    v_mfma_f32_16x16x32_bf16 v[20:23], v[40:43], a[148:151], v[20:23]
    v_mfma_f32_16x16x32_bf16 v[24:27], v[40:43], a[164:167], v[24:27]
    v_mfma_f32_16x16x32_bf16 v[28:31], v[40:43], a[180:183], v[28:31]
    v_cndmask_b32 v36, 0, v32, s[60:61]
    v_cndmask_b32 v37, 0, v33, s[60:61]
    v_cndmask_b32 v38, 0, v34, s[60:61]
    v_cndmask_b32 v39, 0, v35, s[60:61]
    s_nop 1
    v_mfma_f32_16x16x32_bf16 v[16:19], v[36:39], a[136:139], v[16:19]
    v_mfma_f32_16x16x32_bf16 v[20:23], v[36:39], a[152:155], v[20:23]
    v_mfma_f32_16x16x32_bf16 v[24:27], v[36:39], a[168:171], v[24:27]
    v_mfma_f32_16x16x32_bf16 v[28:31], v[36:39], a[184:187], v[28:31]
    v_cndmask_b32 v40, 0, v32, s[62:63]
    v_cndmask_b32 v41, 0, v33, s[62:63]
    v_cndmask_b32 v42, 0, v34, s[62:63]
    v_cndmask_b32 v43, 0, v35, s[62:63]
    s_nop 1
    v_mfma_f32_16x16x32_bf16 v[16:19], v[40:43], a[140:143], v[16:19]
    v_mfma_f32_16x16x32_bf16 v[20:23], v[40:43], a[156:159], v[20:23]
    v_mfma_f32_16x16x32_bf16 v[24:27], v[40:43], a[172:175], v[24:27]
    v_mfma_f32_16x16x32_bf16 v[28:31], v[40:43], a[188:191], v[28:31]
    s_waitcnt vmcnt(4)
    s_call_b64 s[66:67], L_issue
    s_waitcnt vmcnt(4)
    s_call_b64 s[66:67], L_issue
    v_add_u32 v6, s46, v5
    ds_read_b64 v[32:33], v7 offset:896
    ds_read_b64_tr_b16 v[48:49], v6 offset:0
    ds_read_b64_tr_b16 v[50:51], v6 offset:1024
    ds_read_b64_tr_b16 v[52:53], v6 offset:2048
    ds_read_b64_tr_b16 v[54:55], v6 offset:3072
    ds_read_b64_tr_b16 v[56:57], v6 offset:256
    ds_read_b64_tr_b16 v[58:59], v6 offset:1280
    ds_read_b64_tr_b16 v[60:61], v6 offset:2304
    ds_read_b64_tr_b16 v[62:63], v6 offset:3328
    s_waitcnt lgkmcnt(8)
    v_cndmask_b32 v36, 0, v32, s[56:57]
    v_cndmask_b32 v37, 0, v33, s[56:57]
    v_cndmask_b32 v38, 0, v32, s[58:59]
    v_cndmask_b32 v39, 0, v33, s[58:59]
    s_waitcnt lgkmcnt(0)
    v_mfma_f32_16x16x16_bf16 v[16:19], v[36:37], v[48:49], v[16:19]
    v_mfma_f32_16x16x16_bf16 v[20:23], v[36:37], v[50:51], v[20:23]
    v_mfma_f32_16x16x16_bf16 v[24:27], v[36:37], v[52:53], v[24:27]
    v_mfma_f32_16x16x16_bf16 v[28:31], v[36:37], v[54:55], v[28:31]
    v_mfma_f32_16x16x16_bf16 v[16:19], v[38:39], v[56:57], v[16:19]
    v_mfma_f32_16x16x16_bf16 v[20:23], v[38:39], v[58:59], v[20:23]
    v_mfma_f32_16x16x16_bf16 v[24:27], v[38:39], v[60:61], v[24:27]
    v_mfma_f32_16x16x16_bf16 v[28:31], v[38:39], v[62:63], v[28:31]
    ds_read_b64_tr_b16 v[48:49], v6 offset:512
    ds_read_b64_tr_b16 v[50:51], v6 offset:1536
    ds_read_b64_tr_b16 v[52:53], v6 offset:2560
    ds_read_b64_tr_b16 v[54:55], v6 offset:3584
    ds_read_b64_tr_b16 v[56:57], v6 offset:768
    ds_read_b64_tr_b16 v[58:59], v6 offset:1792
    ds_read_b64_tr_b16 v[60:61], v6 offset:2816
    ds_read_b64_tr_b16 v[62:63], v6 offset:3840
    v_cndmask_b32 v36, 0, v32, s[60:61]
    v_cndmask_b32 v37, 0, v33, s[60:61]
    v_cndmask_b32 v38, 0, v32, s[62:63]
    v_cndmask_b32 v39, 0, v33, s[62:63]
    s_waitcnt lgkmcnt(0)
    v_mfma_f32_16x16x16_bf16 v[16:19], v[36:37], v[48:49], v[16:19]
    v_mfma_f32_16x16x16_bf16 v[20:23], v[36:37], v[50:51], v[20:23]
    v_mfma_f32_16x16x16_bf16 v[24:27], v[36:37], v[52:53], v[24:27]
    v_mfma_f32_16x16x16_bf16 v[28:31], v[36:37], v[54:55], v[28:31]
    v_mfma_f32_16x16x16_bf16 v[16:19], v[38:39], v[56:57], v[16:19]
    v_mfma_f32_16x16x16_bf16 v[20:23], v[38:39], v[58:59], v[20:23]
    v_mfma_f32_16x16x16_bf16 v[24:27], v[38:39], v[60:61], v[24:27]
    v_mfma_f32_16x16x16_bf16 v[28:31], v[38:39], v[62:63], v[28:31]
    s_add_u32 s46, s46, 8192
    s_cmp_eq_u32 s46, s42
    s_cselect_b32 s46, s41, s46
    s_waitcnt vmcnt(4)
    s_call_b64 s[66:67], L_issue
    s_waitcnt vmcnt(4)
    s_call_b64 s[66:67], L_issue
    v_add_u32 v6, s46, v5
    ds_read_b64 v[32:33], v7 offset:928
    ds_read_b64_tr_b16 v[48:49], v6 offset:0
    ds_read_b64_tr_b16 v[50:51], v6 offset:1024
    ds_read_b64_tr_b16 v[52:53], v6 offset:2048
    ds_read_b64_tr_b16 v[54:55], v6 offset:3072
    ds_read_b64_tr_b16 v[56:57], v6 offset:256
    ds_read_b64_tr_b16 v[58:59], v6 offset:1280
    ds_read_b64_tr_b16 v[60:61], v6 offset:2304
    ds_read_b64_tr_b16 v[62:63], v6 offset:3328
    s_waitcnt lgkmcnt(8)
    v_cndmask_b32 v36, 0, v32, s[56:57]
    v_cndmask_b32 v37, 0, v33, s[56:57]
    v_cndmask_b32 v38, 0, v32, s[58:59]
    v_cndmask_b32 v39, 0, v33, s[58:59]
    s_waitcnt lgkmcnt(0)
    v_mfma_f32_16x16x16_bf16 v[16:19], v[36:37], v[48:49], v[16:19]
    v_mfma_f32_16x16x16_bf16 v[20:23], v[36:37], v[50:51], v[20:23]
    v_mfma_f32_16x16x16_bf16 v[24:27], v[36:37], v[52:53], v[24:27]
    v_mfma_f32_16x16x16_bf16 v[28:31], v[36:37], v[54:55], v[28:31]
    v_mfma_f32_16x16x16_bf16 v[16:19], v[38:39], v[56:57], v[16:19]
    v_mfma_f32_16x16x16_bf16 v[20:23], v[38:39], v[58:59], v[20:23]
    v_mfma_f32_16x16x16_bf16 v[24:27], v[38:39], v[60:61], v[24:27]
    v_mfma_f32_16x16x16_bf16 v[28:31], v[38:39], v[62:63], v[28:31]
    ds_read_b64_tr_b16 v[48:49], v6 offset:512
    ds_read_b64_tr_b16 v[50:51], v6 offset:1536
    ds_read_b64_tr_b16 v[52:53], v6 offset:2560
    ds_read_b64_tr_b16 v[54:55], v6 offset:3584
    ds_read_b64_tr_b16 v[56:57], v6 offset:768
    ds_read_b64_tr_b16 v[58:59], v6 offset:1792
    ds_read_b64_tr_b16 v[60:61], v6 offset:2816
    ds_read_b64_tr_b16 v[62:63], v6 offset:3840
    v_cndmask_b32 v36, 0, v32, s[60:61]
    v_cndmask_b32 v37, 0, v33, s[60:61]
    v_cndmask_b32 v38, 0, v32, s[62:63]
    v_cndmask_b32 v39, 0, v33, s[62:63]
    s_waitcnt lgkmcnt(0)
    v_mfma_f32_16x16x16_bf16 v[16:19], v[36:37], v[48:49], v[16:19]
    v_mfma_f32_16x16x16_bf16 v[20:23], v[36:37], v[50:51], v[20:23]
    v_mfma_f32_16x16x16_bf16 v[24:27], v[36:37], v[52:53], v[24:27]
    v_mfma_f32_16x16x16_bf16 v[28:31], v[36:37], v[54:55], v[28:31]
    v_mfma_f32_16x16x16_bf16 v[16:19], v[38:39], v[56:57], v[16:19]
    v_mfma_f32_16x16x16_bf16 v[20:23], v[38:39], v[58:59], v[20:23]
    v_mfma_f32_16x16x16_bf16 v[24:27], v[38:39], v[60:61], v[24:27]
    v_mfma_f32_16x16x16_bf16 v[28:31], v[38:39], v[62:63], v[28:31]
    s_add_u32 s46, s46, 8192
    s_cmp_eq_u32 s46, s42
    s_cselect_b32 s46, s41, s46
    s_waitcnt vmcnt(4)
    s_call_b64 s[66:67], L_issue
    s_waitcnt vmcnt(4)
    s_call_b64 s[66:67], L_issue
    v_add_u32 v6, s46, v5
    ds_read_b64 v[32:33], v7 offset:960
    ds_read_b64_tr_b16 v[48:49], v6 offset:0
    ds_read_b64_tr_b16 v[50:51], v6 offset:1024
    ds_read_b64_tr_b16 v[52:53], v6 offset:2048
    ds_read_b64_tr_b16 v[54:55], v6 offset:3072
    ds_read_b64_tr_b16 v[56:57], v6 offset:256
    ds_read_b64_tr_b16 v[58:59], v6 offset:1280
    ds_read_b64_tr_b16 v[60:61], v6 offset:2304
    ds_read_b64_tr_b16 v[62:63], v6 offset:3328
    s_waitcnt lgkmcnt(8)
    v_cndmask_b32 v36, 0, v32, s[56:57]
    v_cndmask_b32 v37, 0, v33, s[56:57]
    v_cndmask_b32 v38, 0, v32, s[58:59]
    v_cndmask_b32 v39, 0, v33, s[58:59]
    s_waitcnt lgkmcnt(0)
    v_mfma_f32_16x16x16_bf16 v[16:19], v[36:37], v[48:49], v[16:19]
    v_mfma_f32_16x16x16_bf16 v[20:23], v[36:37], v[50:51], v[20:23]
    v_mfma_f32_16x16x16_bf16 v[24:27], v[36:37], v[52:53], v[24:27]
    v_mfma_f32_16x16x16_bf16 v[28:31], v[36:37], v[54:55], v[28:31]
    v_mfma_f32_16x16x16_bf16 v[16:19], v[38:39], v[56:57], v[16:19]
    v_mfma_f32_16x16x16_bf16 v[20:23], v[38:39], v[58:59], v[20:23]
    v_mfma_f32_16x16x16_bf16 v[24:27], v[38:39], v[60:61], v[24:27]
    v_mfma_f32_16x16x16_bf16 v[28:31], v[38:39], v[62:63], v[28:31]
    ds_read_b64_tr_b16 v[48:49], v6 offset:512
    ds_read_b64_tr_b16 v[50:51], v6 offset:1536
    ds_read_b64_tr_b16 v[52:53], v6 offset:2560
    ds_read_b64_tr_b16 v[54:55], v6 offset:3584
    ds_read_b64_tr_b16 v[56:57], v6 offset:768
    ds_read_b64_tr_b16 v[58:59], v6 offset:1792
    ds_read_b64_tr_b16 v[60:61], v6 offset:2816
    ds_read_b64_tr_b16 v[62:63], v6 offset:3840
    v_cndmask_b32 v36, 0, v32, s[60:61]
    v_cndmask_b32 v37, 0, v33, s[60:61]
    v_cndmask_b32 v38, 0, v32, s[62:63]
    v_cndmask_b32 v39, 0, v33, s[62:63]
    s_waitcnt lgkmcnt(0)
    v_mfma_f32_16x16x16_bf16 v[16:19], v[36:37], v[48:49], v[16:19]
    v_mfma_f32_16x16x16_bf16 v[20:23], v[36:37], v[50:51], v[20:23]
    v_mfma_f32_16x16x16_bf16 v[24:27], v[36:37], v[52:53], v[24:27]
    v_mfma_f32_16x16x16_bf16 v[28:31], v[36:37], v[54:55], v[28:31]
    v_mfma_f32_16x16x16_bf16 v[16:19], v[38:39], v[56:57], v[16:19]
    v_mfma_f32_16x16x16_bf16 v[20:23], v[38:39], v[58:59], v[20:23]
    v_mfma_f32_16x16x16_bf16 v[24:27], v[38:39], v[60:61], v[24:27]
    v_mfma_f32_16x16x16_bf16 v[28:31], v[38:39], v[62:63], v[28:31]
    s_add_u32 s46, s46, 8192
    s_cmp_eq_u32 s46, s42
    s_cselect_b32 s46, s41, s46
    ds_read2_b64 v[32:35], v7 offset0:80 offset1:88
    s_waitcnt lgkmcnt(0)
    v_cndmask_b32 v36, 0, v32, s[56:57]
    v_cndmask_b32 v37, 0, v33, s[56:57]
    v_cndmask_b32 v38, 0, v34, s[56:57]
    v_cndmask_b32 v39, 0, v35, s[56:57]
    s_nop 1
    v_mfma_f32_16x16x32_bf16 v[16:19], v[36:39], a[192:195], v[16:19]
    v_mfma_f32_16x16x32_bf16 v[20:23], v[36:39], a[208:211], v[20:23]
    v_mfma_f32_16x16x32_bf16 v[24:27], v[36:39], a[224:227], v[24:27]
    v_mfma_f32_16x16x32_bf16 v[28:31], v[36:39], a[240:243], v[28:31]
    v_cndmask_b32 v40, 0, v32, s[58:59]
    v_cndmask_b32 v41, 0, v33, s[58:59]
    v_cndmask_b32 v42, 0, v34, s[58:59]
    v_cndmask_b32 v43, 0, v35, s[58:59]
    s_nop 1
    v_mfma_f32_16x16x32_bf16 v[16:19], v[40:43], a[196:199], v[16:19]
    v_mfma_f32_16x16x32_bf16 v[20:23], v[40:43], a[212:215], v[20:23]
    v_mfma_f32_16x16x32_bf16 v[24:27], v[40:43], a[228:231], v[24:27]
    v_mfma_f32_16x16x32_bf16 v[28:31], v[40:43], a[244:247], v[28:31]
    v_cndmask_b32 v36, 0, v32, s[60:61]
    v_cndmask_b32 v37, 0, v33, s[60:61]
    v_cndmask_b32 v38, 0, v34, s[60:61]
    v_cndmask_b32 v39, 0, v35, s[60:61]
    s_nop 1
    v_mfma_f32_16x16x32_bf16 v[16:19], v[36:39], a[200:203], v[16:19]
    v_mfma_f32_16x16x32_bf16 v[20:23], v[36:39], a[216:219], v[20:23]
    v_mfma_f32_16x16x32_bf16 v[24:27], v[36:39], a[232:235], v[24:27]
    v_mfma_f32_16x16x32_bf16 v[28:31], v[36:39], a[248:251], v[28:31]
    v_cndmask_b32 v40, 0, v32, s[62:63]
    v_cndmask_b32 v41, 0, v33, s[62:63]
    v_cndmask_b32 v42, 0, v34, s[62:63]
    v_cndmask_b32 v43, 0, v35, s[62:63]
    s_nop 1
    v_mfma_f32_16x16x32_bf16 v[16:19], v[40:43], a[204:207], v[16:19]
    v_mfma_f32_16x16x32_bf16 v[20:23], v[40:43], a[220:223], v[20:23]
    v_mfma_f32_16x16x32_bf16 v[24:27], v[40:43], a[236:239], v[24:27]
    v_mfma_f32_16x16x32_bf16 v[28:31], v[40:43], a[252:255], v[28:31]
    s_waitcnt vmcnt(4)
    s_call_b64 s[66:67], L_issue
    s_waitcnt vmcnt(4)
    s_call_b64 s[66:67], L_issue
    v_add_u32 v6, s46, v5
    ds_read_b64 v[32:33], v7 offset:992
    ds_read_b64_tr_b16 v[48:49], v6 offset:0
    ds_read_b64_tr_b16 v[50:51], v6 offset:1024
    ds_read_b64_tr_b16 v[52:53], v6 offset:2048
    ds_read_b64_tr_b16 v[54:55], v6 offset:3072
    ds_read_b64_tr_b16 v[56:57], v6 offset:256
    ds_read_b64_tr_b16 v[58:59], v6 offset:1280
    ds_read_b64_tr_b16 v[60:61], v6 offset:2304
    ds_read_b64_tr_b16 v[62:63], v6 offset:3328
    s_waitcnt lgkmcnt(8)
    v_cndmask_b32 v36, 0, v32, s[56:57]
    v_cndmask_b32 v37, 0, v33, s[56:57]
    v_cndmask_b32 v38, 0, v32, s[58:59]
    v_cndmask_b32 v39, 0, v33, s[58:59]
    s_waitcnt lgkmcnt(0)
    v_mfma_f32_16x16x16_bf16 v[16:19], v[36:37], v[48:49], v[16:19]
    v_mfma_f32_16x16x16_bf16 v[20:23], v[36:37], v[50:51], v[20:23]
    v_mfma_f32_16x16x16_bf16 v[24:27], v[36:37], v[52:53], v[24:27]
    v_mfma_f32_16x16x16_bf16 v[28:31], v[36:37], v[54:55], v[28:31]
    v_mfma_f32_16x16x16_bf16 v[16:19], v[38:39], v[56:57], v[16:19]
    v_mfma_f32_16x16x16_bf16 v[20:23], v[38:39], v[58:59], v[20:23]
    v_mfma_f32_16x16x16_bf16 v[24:27], v[38:39], v[60:61], v[24:27]
    v_mfma_f32_16x16x16_bf16 v[28:31], v[38:39], v[62:63], v[28:31]
    ds_read_b64_tr_b16 v[48:49], v6 offset:512
    ds_read_b64_tr_b16 v[50:51], v6 offset:1536
    ds_read_b64_tr_b16 v[52:53], v6 offset:2560
    ds_read_b64_tr_b16 v[54:55], v6 offset:3584
    ds_read_b64_tr_b16 v[56:57], v6 offset:768
    ds_read_b64_tr_b16 v[58:59], v6 offset:1792
    ds_read_b64_tr_b16 v[60:61], v6 offset:2816
    ds_read_b64_tr_b16 v[62:63], v6 offset:3840
    v_cndmask_b32 v36, 0, v32, s[60:61]
    v_cndmask_b32 v37, 0, v33, s[60:61]
    v_cndmask_b32 v38, 0, v32, s[62:63]
    v_cndmask_b32 v39, 0, v33, s[62:63]
    s_waitcnt lgkmcnt(0)
    v_mfma_f32_16x16x16_bf16 v[16:19], v[36:37], v[48:49], v[16:19]
    v_mfma_f32_16x16x16_bf16 v[20:23], v[36:37], v[50:51], v[20:23]
    v_mfma_f32_16x16x16_bf16 v[24:27], v[36:37], v[52:53], v[24:27]
    v_mfma_f32_16x16x16_bf16 v[28:31], v[36:37], v[54:55], v[28:31]
    v_mfma_f32_16x16x16_bf16 v[16:19], v[38:39], v[56:57], v[16:19]
    v_mfma_f32_16x16x16_bf16 v[20:23], v[38:39], v[58:59], v[20:23]
    v_mfma_f32_16x16x16_bf16 v[24:27], v[38:39], v[60:61], v[24:27]
    v_mfma_f32_16x16x16_bf16 v[28:31], v[38:39], v[62:63], v[28:31]
    s_add_u32 s46, s46, 8192
    s_cmp_eq_u32 s46, s42
    s_cselect_b32 s46, s41, s46
    s_nop 7
L_gapcode:
    v_permlane16_swap_b32 v16, v20
    v_permlane16_swap_b32 v24, v28
    v_permlane16_swap_b32 v17, v21
    v_permlane16_swap_b32 v25, v29
    v_permlane16_swap_b32 v18, v22
    v_permlane16_swap_b32 v26, v30
    v_permlane16_swap_b32 v19, v23
    v_permlane16_swap_b32 v27, v31
    s_nop 1
    v_permlane32_swap_b32 v16, v24
    v_permlane32_swap_b32 v17, v25
    v_permlane32_swap_b32 v18, v26
    v_permlane32_swap_b32 v19, v27
    v_lshrrev_b32 v32, 4, v0
    v_lshlrev_b32 v32, 8, v32
    v_and_b32 v33, 15, v0
    v_lshl_add_u32 v32, v33, 2, v32
    s_lshl_b32 s70, s3, 10
    s_add_u32 s70, s70, 3072
    v_add_u32 v32, s70, v32
    ds_write_b32 v32, v16 offset:0
    ds_write_b32 v32, v17 offset:64
    ds_write_b32 v32, v18 offset:128
    ds_write_b32 v32, v19 offset:192
    s_lshl_b32 s70, s3, 2
    s_add_u32 s70, s70, 2704
    v_mov_b32 v33, s70
    ds_write_b32 v33, v8
    s_waitcnt lgkmcnt(0)
    s_barrier
    s_lshl_b32 s70, s3, 8
    s_add_u32 s70, s70, 3072
    v_lshlrev_b32 v40, 2, v0
    v_add_u32 v32, s70, v40
    ds_read_b32 v34, v32 offset:0
    ds_read_b32 v35, v32 offset:1024
    ds_read_b32 v36, v32 offset:2048
    ds_read_b32 v37, v32 offset:3072
    v_mov_b32 v33, 2704
    ds_read_b128 v[44:47], v33
    s_waitcnt lgkmcnt(0)
    v_add_f32 v34, v34, v35
    v_add_f32 v36, v36, v37
    v_add_f32 v34, v34, v36
    v_add_f32 v44, v44, v45
    v_add_f32 v46, v46, v47
    v_add_f32 v44, v44, v46
    v_mov_b32 v41, -2
    v_min_u32 v34, v34, v41
    v_and_b32 v42, 1, v0
    v_cmp_eq_u32 vcc, 1, v42
    s_nop 1
    v_cndmask_b32 v43, v9, v44, vcc
    v_min_u32 v43, v43, v41
    v_lshlrev_b32 v42, 2, v42
    v_add_u32 v42, 256, v42
    s_lshl_b32 s70, s50, 2
    s_add_u32 s70, s70, s3
    s_lshl_b32 s70, s70, 4
    s_add_u32 s70, s70, s51
    s_mul_i32 s70, s70, 384
    s_mul_i32 s71, s47, 0x60000
    s_add_u32 s76, s30, 0
    s_addc_u32 s77, s31, 0
    s_add_u32 s76, s76, s70
    s_addc_u32 s77, s77, 0
    s_add_u32 s76, s76, s71
    s_addc_u32 s77, s77, 0
    global_store_dword v40, v34, s[76:77] sc1
    global_store_dword v42, v43, s[76:77] sc1
    s_barrier
    s_cmp_eq_u32 s48, 1
    s_cbranch_scc1 L_roleO
    s_cmp_eq_u32 s48, 4
    s_cbranch_scc1 L_roleD
    s_cmp_eq_u32 s47, 0
    s_cbranch_scc0 Lgw_16
    s_cmp_eq_u32 s48, 0
    s_cbranch_scc1 Lgw_16
    s_mov_b32 s87, 0x20000
    s_mov_b64 s[82:83], -1
    s_mov_b32 s84, s24
    s_and_b32 s85, s25, 0xffff
    s_mov_b32 s86, 0
    s_mov_b32 s94, s53
    s_mov_b32 s95, 0
    s_mov_b32 s96, 0
    s_mov_b32 s97, 0
    s_mov_b32 s98, 0
    s_mov_b32 s7, 99
    s_mov_b32 s6, 0
    s_mov_b64 s[4:5], 0
    v_mov_b32 v12, 0
    s_cmp_eq_u32 s48, 0
    s_cbranch_scc1 L_wdone_gap
    s_mov_b32 s95, 1024
    s_cmp_eq_u32 s48, 2
    s_cbranch_scc1 L_wB_gap
    s_branch L_wC_gap
L_wC_gap:
    s_mov_b32 s84, s24
    s_and_b32 s85, s25, 0xffff
    s_mov_b32 s86, 1605632
    v_lshrrev_b32 v9, 1, v0
    v_mul_u32_u24 v12, 896, v9
    v_and_b32 v9, 1, v0
    v_lshl_add_u32 v12, v9, 4, v12
    s_mul_i32 s71, s3, 401408
    s_lshl_b32 s72, s49, 5
    s_add_u32 s96, s71, s72
    s_mov_b32 s98, 28672
    s_mul_i32 s94, s3, 14336
    s_add_u32 s94, s94, 7168
    s_mov_b32 s97, s96
    s_mov_b32 s6, s94
    s_and_b32 s70, s49, 3
    s_mul_i32 s70, s70, 7
    s_add_u32 s70, s70, 1
    s_lshr_b32 s70, s70, 1
    s_sub_u32 s7, 14, s70
    s_mul_i32 s71, s70, 28672
    s_add_u32 s96, s96, s71
    s_lshl_b32 s71, s70, 10
    s_add_u32 s94, s94, s71
    s_branch L_wdone_gap
L_wB_gap:
    s_bitcmp1_b32 s49, 0
    s_cselect_b32 s84, s22, s20
    s_cselect_b32 s85, s23, s21
    s_cselect_b32 s4, s20, s22
    s_cselect_b32 s5, s21, s23
    s_cselect_b32 s73, 28704, 0
    s_cselect_b32 s74, 0, 28704
    s_and_b32 s85, s85, 0xffff
    s_and_b32 s5, s5, 0xffff
    s_mov_b32 s86, 1605632
    v_lshrrev_b32 v9, 2, v0
    v_mul_u32_u24 v12, 3584, v9
    v_and_b32 v9, 3, v0
    v_lshl_add_u32 v12, v9, 4, v12
    s_mul_i32 s71, s3, 401408
    s_lshl_b32 s72, s49, 6
    s_add_u32 s96, s71, s72
    s_mov_b32 s97, s96
    s_mov_b32 s98, 57344
    s_mul_i32 s94, s3, 7168
    s_add_u32 s94, s94, 7168
    s_add_u32 s6, s94, s74
    s_add_u32 s94, s94, s73
L_wdone_gap:
    s_mov_b32 m0, s94
    s_add_u32 s94, s94, s95
    s_mov_b64 exec, s[82:83]
    buffer_load_dwordx4 v12, s[84:87], s96 offen lds
    s_mov_b64 exec, -1
    s_add_u32 s96, s96, s98
    s_cmp_eq_u32 s7, 1
    s_cselect_b32 s96, s97, s96
    s_cselect_b32 s94, s6, s94
    s_mov_b32 m0, s94
    s_add_u32 s94, s94, s95
    s_mov_b64 exec, s[82:83]
    buffer_load_dwordx4 v12, s[84:87], s96 offen lds
    s_mov_b64 exec, -1
    s_add_u32 s96, s96, s98
    s_cmp_eq_u32 s7, 2
    s_cselect_b32 s96, s97, s96
    s_cselect_b32 s94, s6, s94
    s_mov_b32 m0, s94
    s_add_u32 s94, s94, s95
    s_mov_b64 exec, s[82:83]
    buffer_load_dwordx4 v12, s[84:87], s96 offen lds
    s_mov_b64 exec, -1
    s_add_u32 s96, s96, s98
    s_cmp_eq_u32 s7, 3
    s_cselect_b32 s96, s97, s96
    s_cselect_b32 s94, s6, s94
    s_mov_b32 m0, s94
    s_add_u32 s94, s94, s95
    s_mov_b64 exec, s[82:83]
    buffer_load_dwordx4 v12, s[84:87], s96 offen lds
    s_mov_b64 exec, -1
    s_add_u32 s96, s96, s98
    s_cmp_eq_u32 s7, 4
    s_cselect_b32 s96, s97, s96
    s_cselect_b32 s94, s6, s94
    s_mov_b32 m0, s94
    s_add_u32 s94, s94, s95
    s_mov_b64 exec, s[82:83]
    buffer_load_dwordx4 v12, s[84:87], s96 offen lds
    s_mov_b64 exec, -1
    s_add_u32 s96, s96, s98
    s_cmp_eq_u32 s7, 5
    s_cselect_b32 s96, s97, s96
    s_cselect_b32 s94, s6, s94
    s_mov_b32 m0, s94
    s_add_u32 s94, s94, s95
    s_mov_b64 exec, s[82:83]
    buffer_load_dwordx4 v12, s[84:87], s96 offen lds
    s_mov_b64 exec, -1
    s_add_u32 s96, s96, s98
    s_cmp_eq_u32 s7, 6
    s_cselect_b32 s96, s97, s96
    s_cselect_b32 s94, s6, s94
    s_mov_b32 m0, s94
    s_add_u32 s94, s94, s95
    s_mov_b64 exec, s[82:83]
    buffer_load_dwordx4 v12, s[84:87], s96 offen lds
    s_mov_b64 exec, -1
    s_add_u32 s96, s96, s98
    s_cmp_eq_u32 s48, 2
    s_cselect_b32 s84, s4, s84
    s_cselect_b32 s85, s5, s85
    s_cselect_b32 s96, s97, s96
    s_cselect_b32 s94, s6, s94
    s_cmp_eq_u32 s7, 7
    s_cselect_b32 s96, s97, s96
    s_cselect_b32 s94, s6, s94
    s_mov_b32 m0, s94
    s_add_u32 s94, s94, s95
    s_mov_b64 exec, s[82:83]
    buffer_load_dwordx4 v12, s[84:87], s96 offen lds
    s_mov_b64 exec, -1
    s_add_u32 s96, s96, s98
    s_cmp_eq_u32 s7, 8
    s_cselect_b32 s96, s97, s96
    s_cselect_b32 s94, s6, s94
    s_mov_b32 m0, s94
    s_add_u32 s94, s94, s95
    s_mov_b64 exec, s[82:83]
    buffer_load_dwordx4 v12, s[84:87], s96 offen lds
    s_mov_b64 exec, -1
    s_add_u32 s96, s96, s98
    s_cmp_eq_u32 s7, 9
    s_cselect_b32 s96, s97, s96
    s_cselect_b32 s94, s6, s94
    s_mov_b32 m0, s94
    s_add_u32 s94, s94, s95
    s_mov_b64 exec, s[82:83]
    buffer_load_dwordx4 v12, s[84:87], s96 offen lds
    s_mov_b64 exec, -1
    s_add_u32 s96, s96, s98
    s_cmp_eq_u32 s7, 10
    s_cselect_b32 s96, s97, s96
    s_cselect_b32 s94, s6, s94
    s_mov_b32 m0, s94
    s_add_u32 s94, s94, s95
    s_mov_b64 exec, s[82:83]
    buffer_load_dwordx4 v12, s[84:87], s96 offen lds
    s_mov_b64 exec, -1
    s_add_u32 s96, s96, s98
    s_cmp_eq_u32 s7, 11
    s_cselect_b32 s96, s97, s96
    s_cselect_b32 s94, s6, s94
    s_mov_b32 m0, s94
    s_add_u32 s94, s94, s95
    s_mov_b64 exec, s[82:83]
    buffer_load_dwordx4 v12, s[84:87], s96 offen lds
    s_mov_b64 exec, -1
    s_add_u32 s96, s96, s98
    s_cmp_eq_u32 s7, 12
    s_cselect_b32 s96, s97, s96
    s_cselect_b32 s94, s6, s94
    s_mov_b32 m0, s94
    s_add_u32 s94, s94, s95
    s_mov_b64 exec, s[82:83]
    buffer_load_dwordx4 v12, s[84:87], s96 offen lds
    s_mov_b64 exec, -1
    s_add_u32 s96, s96, s98
    s_cmp_eq_u32 s7, 13
    s_cselect_b32 s96, s97, s96
    s_cselect_b32 s94, s6, s94
    s_mov_b32 m0, s94
    s_add_u32 s94, s94, s95
    s_mov_b64 exec, s[82:83]
    buffer_load_dwordx4 v12, s[84:87], s96 offen lds
    s_mov_b64 exec, -1
    s_add_u32 s96, s96, s98
Lgw_16:
    s_cmp_eq_u32 s48, 2
    s_cbranch_scc1 L_roleB
    s_cmp_eq_u32 s48, 3
    s_cbranch_scc1 L_roleC
    s_cmp_eq_u32 s47, 0
    s_cbranch_scc0 Tud_18
    s_sub_u32 s75, s52, 2
Tu_17:
    s_waitcnt vmcnt(0)
    s_call_b64 s[66:67], L_issue
    s_sub_u32 s75, s75, 1
    s_cmp_lg_u32 s75, 0
    s_cbranch_scc1 Tu_17
Tud_18:
    s_cmp_eq_u32 s47, 0
    s_cbranch_scc0 Lpfd_19
    v_lshrrev_b32 v6, 5, v0
    v_lshlrev_b32 v6, 14, v6
    v_and_b32 v5, 31, v0
    v_lshlrev_b32 v5, 7, v5
    v_add_u32 v5, 3072, v5
    s_cmp_eq_u32 s52, 8
    s_cselect_b32 s70, 8, 6
    s_lshl_b32 s71, s70, 11
    s_xor_b32 s71, s71, s17
    s_and_b32 s71, s71, 8192
    s_lshl_b32 s70, s70, 14
    s_add_u32 s70, s70, s101
    v_add_u32 v7, s70, v6
    v_and_b32 v7, 0xfffff, v7
    v_add_u32 v7, v7, v5
    s_waitcnt vmcnt(0)
    buffer_load_dword v8, v7, s[36:39], s71 offen
    s_cmp_eq_u32 s52, 8
    s_cselect_b32 s70, 12, 8
    s_lshl_b32 s71, s70, 11
    s_xor_b32 s71, s71, s17
    s_and_b32 s71, s71, 8192
    s_lshl_b32 s70, s70, 14
    s_add_u32 s70, s70, s101
    v_add_u32 v7, s70, v6
    v_and_b32 v7, 0xfffff, v7
    v_add_u32 v7, v7, v5
    s_waitcnt vmcnt(0)
    buffer_load_dword v8, v7, s[36:39], s71 offen
    s_cmp_eq_u32 s52, 8
    s_cselect_b32 s70, 16, 12
    s_lshl_b32 s71, s70, 11
    s_xor_b32 s71, s71, s17
    s_and_b32 s71, s71, 8192
    s_lshl_b32 s70, s70, 14
    s_add_u32 s70, s70, s101
    v_add_u32 v7, s70, v6
    v_and_b32 v7, 0xfffff, v7
    v_add_u32 v7, v7, v5
    s_waitcnt vmcnt(0)
    buffer_load_dword v8, v7, s[36:39], s71 offen
    s_waitcnt vmcnt(0)
Lpfd_19:
    s_branch L_next
L_roleO:
    v_lshrrev_b32 v28, 4, v0
    v_bfe_u32 v29, v0, 2, 2
    v_and_b32 v30, 3, v0
    v_lshlrev_b32 v6, 3, v28
    v_add_u32 v6, s53, v6
    v_lshl_add_u32 v7, v28, 2, v29
    v_mul_u32_u24 v7, 912, v7
    v_lshl_add_u32 v7, v30, 3, v7
    s_mul_i32 s70, s3, 224
    s_add_u32 s70, s70, 7168
    v_add_u32 v7, s70, v7
    v_and_b32 v5, 15, v0
    v_lshlrev_b32 v5, 3, v5
    v_lshrrev_b32 v9, 5, v0
    v_lshl_add_u32 v5, v9, 2, v5
    v_add_u32 v5, s53, v5
    s_mul_i32 s70, s49, 2048
    s_mul_i32 s71, s47, 0x20000
    s_lshl_b32 s72, s3, 9
    s_add_u32 s78, s30, 0x100000
    s_addc_u32 s79, s31, 0
    s_add_u32 s78, s78, s70
    s_addc_u32 s79, s79, 0
    s_add_u32 s78, s78, s71
    s_addc_u32 s79, s79, 0
    s_add_u32 s78, s78, s72
    s_addc_u32 s79, s79, 0
    s_mul_i32 s70, s49, 6144
    s_mul_i32 s71, s47, 0x60000
    s_add_u32 s76, s30, 0x900
    s_addc_u32 s77, s31, 0
    s_add_u32 s76, s76, s70
    s_addc_u32 s77, s77, 0
    s_add_u32 s76, s76, s71
    s_addc_u32 s77, s77, 0
    v_mul_u32_u24 v10, 384, v28
    v_and_b32 v11, 15, v0
    v_lshl_add_u32 v11, v11, 4, v10
    v_add_u32 v10, 256, v10
    s_mov_b32 s73, 0x3db8aa3b
    s_mov_b32 s55, 0
Ps1_20:
    global_load_dwordx2 v[48:49], v10, s[76:77] offset:-2304 sc1
    global_load_dwordx4 v[32:35], v11, s[76:77] offset:-2304 sc1
    global_load_dwordx2 v[50:51], v10, s[76:77] offset:-768 sc1
    global_load_dwordx4 v[36:39], v11, s[76:77] offset:-768 sc1
    global_load_dwordx2 v[52:53], v10, s[76:77] offset:768 sc1
    global_load_dwordx4 v[40:43], v11, s[76:77] offset:768 sc1
    global_load_dwordx2 v[54:55], v10, s[76:77] offset:2304 sc1
    global_load_dwordx4 v[44:47], v11, s[76:77] offset:2304 sc1
    s_waitcnt vmcnt(0)
    v_max3_u32 v56, v32, v33, v34
    v_max3_u32 v56, v56, v35, v36
    v_max3_u32 v56, v56, v37, v38
    v_max3_u32 v56, v56, v39, v40
    v_max3_u32 v56, v56, v41, v42
    v_max3_u32 v56, v56, v43, v44
    v_max3_u32 v56, v56, v45, v46
    v_max3_u32 v56, v56, v47, v48
    v_max3_u32 v56, v56, v49, v50
    v_max3_u32 v56, v56, v51, v52
    v_max3_u32 v56, v56, v53, v54
    v_max_u32 v56, v56, v55
    v_cmp_eq_u32 vcc, -1, v56
    s_cbranch_vccz Ps1d_21
    s_add_u32 s55, s55, 1
    s_cmp_lt_u32 s55, 262144
    s_cbranch_scc1 Ps1_20
Ps1d_21:
    v_max3_f32 v56, v48, v50, v52
    v_max_f32 v56, v56, v54
    v_mov_b32 v57, v56
    s_nop 1
    v_permlane16_swap_b32 v56, v57
    v_max_f32 v56, v56, v57
    v_mov_b32 v57, v56
    s_nop 1
    v_permlane32_swap_b32 v56, v57
    v_max_f32 v56, v56, v57
    v_sub_f32 v48, v48, v56
    v_sub_f32 v50, v50, v56
    v_sub_f32 v52, v52, v56
    v_sub_f32 v54, v54, v56
    v_mul_f32 v48, s73, v48
    v_mul_f32 v50, s73, v50
    v_mul_f32 v52, s73, v52
    v_mul_f32 v54, s73, v54
    v_exp_f32 v48, v48
    v_exp_f32 v50, v50
    v_exp_f32 v52, v52
    v_exp_f32 v54, v54
    s_nop 0
    v_mul_f32 v56, v48, v49
    v_pk_mul_f32 v[32:33], v[32:33], v[48:49] op_sel_hi:[1,0]
    v_pk_mul_f32 v[34:35], v[34:35], v[48:49] op_sel_hi:[1,0]
    v_fmac_f32 v56, v50, v51
    v_pk_fma_f32 v[32:33], v[36:37], v[50:51], v[32:33] op_sel_hi:[1,0,1]
    v_pk_fma_f32 v[34:35], v[38:39], v[50:51], v[34:35] op_sel_hi:[1,0,1]
    v_fmac_f32 v56, v52, v53
    v_pk_fma_f32 v[32:33], v[40:41], v[52:53], v[32:33] op_sel_hi:[1,0,1]
    v_pk_fma_f32 v[34:35], v[42:43], v[52:53], v[34:35] op_sel_hi:[1,0,1]
    v_fmac_f32 v56, v54, v55
    v_pk_fma_f32 v[32:33], v[44:45], v[54:55], v[32:33] op_sel_hi:[1,0,1]
    v_pk_fma_f32 v[34:35], v[46:47], v[54:55], v[34:35] op_sel_hi:[1,0,1]
    v_mov_b32 v57, v56
    s_nop 0
    v_permlane32_swap_b32 v32, v34
    v_permlane32_swap_b32 v33, v35
    v_permlane32_swap_b32 v56, v57
    v_add_f32 v32, v32, v34
    v_add_f32 v33, v33, v35
    v_add_f32 v56, v56, v57
    v_mov_b32 v34, v32
    v_mov_b32 v35, v33
    v_mov_b32 v57, v56
    s_nop 0
    v_permlane16_swap_b32 v32, v34
    v_permlane16_swap_b32 v33, v35
    v_permlane16_swap_b32 v56, v57
    v_add_f32 v56, v56, v57
    v_add_f32 v32, v32, v34
    v_rcp_f32 v56, v56
    v_add_f32 v33, v33, v35
    s_nop 0
    v_pk_mul_f32 v[32:33], v[32:33], v[56:57] op_sel_hi:[1,0]
    v_cvt_pk_bf16_f32 v32, v32, v33
    ds_write_b32 v5, v32
    ds_read_b64_tr_b16 v[44:45], v7 offset:0
    ds_read_b64_tr_b16 v[46:47], v7 offset:14592
    ds_read_b64_tr_b16 v[48:49], v7 offset:29184
    ds_read_b64_tr_b16 v[50:51], v7 offset:43776
    ds_read_b64_tr_b16 v[52:53], v7 offset:32
    ds_read_b64_tr_b16 v[54:55], v7 offset:14624
    ds_read_b64_tr_b16 v[56:57], v7 offset:29216
    ds_read_b64_tr_b16 v[58:59], v7 offset:43808
    ds_read_b64_tr_b16 v[60:61], v7 offset:64
    ds_read_b64_tr_b16 v[62:63], v7 offset:14656
    s_waitcnt lgkmcnt(10)
    ds_read2_b64 v[36:39], v6 offset0:0 offset1:4
    ds_read2_b64 v[40:43], v6 offset0:8 offset1:12
    s_waitcnt lgkmcnt(0)
    v_mfma_f32_16x16x32_bf16 v[12:15], v[36:39], v[44:47], 0
    ds_read_b64_tr_b16 v[44:45], v7 offset:29248
    ds_read_b64_tr_b16 v[46:47], v7 offset:43840
    v_mfma_f32_16x16x32_bf16 v[12:15], v[40:43], v[48:51], v[12:15]
    ds_read_b64_tr_b16 v[48:49], v7 offset:96
    ds_read_b64_tr_b16 v[50:51], v7 offset:14688
    v_mfma_f32_16x16x32_bf16 v[16:19], v[36:39], v[52:55], 0
    ds_read_b64_tr_b16 v[52:53], v7 offset:29280
    ds_read_b64_tr_b16 v[54:55], v7 offset:43872
    v_mfma_f32_16x16x32_bf16 v[16:19], v[40:43], v[56:59], v[16:19]
    ds_read_b64_tr_b16 v[56:57], v7 offset:128
    ds_read_b64_tr_b16 v[58:59], v7 offset:14720
    v_mfma_f32_16x16x32_bf16 v[20:23], v[36:39], v[60:63], 0
    ds_read_b64_tr_b16 v[60:61], v7 offset:29312
    ds_read_b64_tr_b16 v[62:63], v7 offset:43904
    s_waitcnt lgkmcnt(8)
    v_mfma_f32_16x16x32_bf16 v[20:23], v[40:43], v[44:47], v[20:23]
    ds_read_b64_tr_b16 v[44:45], v7 offset:160
    ds_read_b64_tr_b16 v[46:47], v7 offset:14752
    s_waitcnt lgkmcnt(8)
    v_mfma_f32_16x16x32_bf16 v[24:27], v[36:39], v[48:51], 0
    ds_read_b64_tr_b16 v[48:49], v7 offset:29344
    ds_read_b64_tr_b16 v[50:51], v7 offset:43936
    s_waitcnt lgkmcnt(8)
    v_mfma_f32_16x16x32_bf16 v[24:27], v[40:43], v[52:55], v[24:27]
    ds_read_b64_tr_b16 v[52:53], v7 offset:192
    ds_read_b64_tr_b16 v[54:55], v7 offset:14784
    s_waitcnt lgkmcnt(8)
    v_mfma_f32_16x16x32_bf16 v[28:31], v[36:39], v[56:59], 0
    ds_read_b64_tr_b16 v[56:57], v7 offset:29376
    ds_read_b64_tr_b16 v[58:59], v7 offset:43968
    s_waitcnt lgkmcnt(8)
    v_mfma_f32_16x16x32_bf16 v[28:31], v[40:43], v[60:63], v[28:31]
    s_waitcnt lgkmcnt(6)
    v_mfma_f32_16x16x32_bf16 v[32:35], v[36:39], v[44:47], 0
    s_waitcnt lgkmcnt(4)
    v_mfma_f32_16x16x32_bf16 v[32:35], v[40:43], v[48:51], v[32:35]
    s_waitcnt lgkmcnt(2)
    v_mfma_f32_16x16x32_bf16 v[8:11], v[36:39], v[52:55], 0
    s_waitcnt lgkmcnt(0)
    v_mfma_f32_16x16x32_bf16 v[8:11], v[40:43], v[56:59], v[8:11]
    s_nop 7
    s_mov_b32 exec_lo, 0xffff0000
    s_mov_b32 exec_hi, 0x0
    v_mov_b32 v12, v16
    v_mov_b32 v28, v32
    s_mov_b32 exec_lo, 0x0
    s_mov_b32 exec_hi, 0xffff
    v_mov_b32 v12, v20
    v_mov_b32 v28, v8
    s_mov_b32 exec_lo, 0x0
    s_mov_b32 exec_hi, 0xffff0000
    v_mov_b32 v12, v24
    s_mov_b64 exec, -1
    v_mov_b32 v41, -2
    v_lshlrev_b32 v42, 2, v0
    v_min_u32 v12, v12, v41
    v_min_u32 v28, v28, v41
    global_store_dword v42, v12, s[78:79] sc1
    s_mov_b32 exec_hi, 0xffff
    global_store_dword v42, v28, s[78:79] offset:256 sc1
    s_mov_b64 exec, -1
    s_cmp_eq_u32 s47, 0
    s_cbranch_scc0 Lpr_22
    s_and_b32 s75, s49, 3
    s_cmp_lt_u32 s75, 2
    s_cbranch_scc0 Lpr_22
    s_waitcnt vmcnt(0)
    s_cmp_eq_u32 s3, 0
    s_cbranch_scc0 Lprb_24
    s_cmp_eq_u32 s75, 1
    s_cselect_b32 s76, s34, s32
    s_cselect_b32 s77, s35, s33
    s_lshr_b32 s70, s49, 2
    s_lshl_b32 s70, s70, 4
    s_and_b32 s71, s2, 7
    s_xor_b32 s71, s71, 4
    s_add_u32 s19, s70, s71
    s_mov_b32 s70, s19
    s_sub_i32 s71, s70, s2
    s_lshl_b32 s71, s71, 20
    s_add_i32 s71, s71, 3072
    s_ashr_i32 s72, s71, 31
    s_add_u32 s76, s76, s71
    s_addc_u32 s77, s77, s72
    s_mul_i32 s74, s70, 3
    s_and_b32 s74, s74, 63
    s_mul_i32 s74, s74, 16384
    s_cmp_eq_u32 s75, 1
    s_cselect_b32 s70, 65, 29
    s_lshr_b32 s71, s19, 3
    s_add_u32 s70, s70, s71
    s_add_u32 s70, s70, 32
    s_sub_u32 s70, 0, s70
    s_and_b32 s70, s70, 1
    s_add_u32 s70, s70, 32
    s_mul_i32 s70, s70, 16384
    s_add_u32 s71, s74, s70
    s_and_b32 s71, s71, 0xfffff
    s_mov_b32 s68, 32768
    s_cmp_eq_u32 s75, 1
    s_cbranch_scc0 Lprk_25
    s_lshr_b32 s71, s19, 3
    s_add_u32 s71, s71, 95
    s_sub_u32 s71, 0, s71
    s_and_b32 s71, s71, 1
    s_add_u32 s71, s71, 2
    s_and_b32 s70, s71, 1
    s_lshl_b32 s71, s71, 1
    s_sub_u32 s71, s71, s70
    s_add_u32 s71, s71, 10
    s_mul_i32 s71, s71, 16384
    s_add_u32 s71, s71, s74
    s_and_b32 s71, s71, 0xfffff
    s_mov_b32 s68, 65536
Lprk_25:
    s_mov_b32 s72, -1
    s_mov_b32 s73, -1
    s_mov_b32 s70, 5
Lprl_23:
    s_add_u32 s74, s71, 1024
    v_mov_b32 v8, s74
    s_memtime s[90:91]
    s_waitcnt lgkmcnt(0)
    s_mov_b32 s74, s90
    global_load_dword v9, v8, s[76:77] nt
    s_waitcnt vmcnt(0)
    s_memtime s[90:91]
    s_waitcnt lgkmcnt(0)
    s_sub_u32 s74, s90, s74
    s_min_u32 s72, s72, s74
    s_add_u32 s74, s71, 9216
    v_mov_b32 v8, s74
    s_memtime s[90:91]
    s_waitcnt lgkmcnt(0)
    s_mov_b32 s74, s90
    global_load_dword v9, v8, s[76:77] nt
    s_waitcnt vmcnt(0)
    s_memtime s[90:91]
    s_waitcnt lgkmcnt(0)
    s_sub_u32 s74, s90, s74
    s_min_u32 s73, s73, s74
    s_add_u32 s71, s71, s68
    s_and_b32 s71, s71, 0xfffff
    s_sub_u32 s70, s70, 1
    s_cmp_lg_u32 s70, 0
    s_cbranch_scc1 Lprl_23
    s_lshr_b32 s70, s19, 1
    s_lshr_b32 s71, s2, 2
    s_xor_b32 s70, s70, s71
    s_and_b32 s70, s70, 1
    s_cmp_gt_u32 s72, s73
    s_cselect_b32 s71, 1, 0
    s_xor_b32 s71, s71, s70
    v_mov_b32 v8, s71
    s_lshr_b32 s70, s49, 2
    s_lshl_b32 s70, s70, 7
    s_lshl_b32 s71, s75, 2
    s_add_u32 s78, s30, 0xd2000
    s_addc_u32 s79, s31, 0
    s_add_u32 s78, s78, s70
    s_addc_u32 s79, s79, 0
    s_add_u32 s78, s78, s71
    s_addc_u32 s79, s79, 0
    v_mov_b32 v9, 0
    s_mov_b64 exec, 1
    global_store_dword v9, v8, s[78:79] sc1
    s_mov_b64 exec, -1
Lprb_24:
    s_barrier
Lpr_22:
    s_cmp_eq_u32 s47, 0
    s_cbranch_scc0 Tud_27
    s_sub_u32 s75, s52, 2
Tu_26:
    s_waitcnt vmcnt(4)
    s_call_b64 s[66:67], L_issue
    s_sub_u32 s75, s75, 1
    s_cmp_lg_u32 s75, 0
    s_cbranch_scc1 Tu_26
Tud_27:
    s_bitcmp1_b32 s49, 1
    s_cbranch_scc0 Lpo_28
    s_cmp_eq_u32 s47, 0
    s_cbranch_scc0 Lpfd_29
    v_lshrrev_b32 v6, 5, v0
    v_lshlrev_b32 v6, 14, v6
    v_and_b32 v5, 31, v0
    v_lshlrev_b32 v5, 7, v5
    v_add_u32 v5, 3072, v5
    s_cmp_eq_u32 s52, 8
    s_cselect_b32 s70, 8, 6
    s_lshl_b32 s71, s70, 11
    s_xor_b32 s71, s71, s17
    s_and_b32 s71, s71, 8192
    s_lshl_b32 s70, s70, 14
    s_add_u32 s70, s70, s101
    v_add_u32 v7, s70, v6
    v_and_b32 v7, 0xfffff, v7
    v_add_u32 v7, v7, v5
    s_waitcnt vmcnt(0)
    buffer_load_dword v8, v7, s[36:39], s71 offen
    s_cmp_eq_u32 s52, 8
    s_cselect_b32 s70, 12, 8
    s_lshl_b32 s71, s70, 11
    s_xor_b32 s71, s71, s17
    s_and_b32 s71, s71, 8192
    s_lshl_b32 s70, s70, 14
    s_add_u32 s70, s70, s101
    v_add_u32 v7, s70, v6
    v_and_b32 v7, 0xfffff, v7
    v_add_u32 v7, v7, v5
    s_waitcnt vmcnt(0)
    buffer_load_dword v8, v7, s[36:39], s71 offen
    s_cmp_eq_u32 s52, 8
    s_cselect_b32 s70, 16, 12
    s_lshl_b32 s71, s70, 11
    s_xor_b32 s71, s71, s17
    s_and_b32 s71, s71, 8192
    s_lshl_b32 s70, s70, 14
    s_add_u32 s70, s70, s101
    v_add_u32 v7, s70, v6
    v_and_b32 v7, 0xfffff, v7
    v_add_u32 v7, v7, v5
    s_waitcnt vmcnt(0)
    buffer_load_dword v8, v7, s[36:39], s71 offen
    s_waitcnt vmcnt(0)
Lpfd_29:
Lpo_28:
    s_branch L_next
L_roleB:
    s_waitcnt vmcnt(0)
    s_barrier
    v_lshrrev_b32 v28, 4, v0
    v_bfe_u32 v29, v0, 2, 2
    v_and_b32 v30, 3, v0
    v_lshlrev_b32 v6, 3, v28
    v_add_u32 v6, s53, v6
    v_lshlrev_b32 v5, 4, v0
    v_add_u32 v5, s53, v5
    v_lshl_add_u32 v7, v28, 2, v29
    v_lshlrev_b32 v7, 6, v7
    v_and_b32 v31, 1, v30
    v_lshl_add_u32 v7, v31, 3, v7
    v_lshrrev_b32 v31, 1, v30
    v_mul_u32_u24 v31, 28704, v31
    v_add_u32 v7, v7, v31
    s_lshl_b32 s70, s3, 4
    s_add_u32 s70, s70, 7168
    v_add_u32 v7, s70, v7
    ds_read_b64_tr_b16 v[32:33], v7 offset:0
    ds_read_b64_tr_b16 v[34:35], v7 offset:1024
    ds_read_b64_tr_b16 v[36:37], v7 offset:2048
    ds_read_b64_tr_b16 v[38:39], v7 offset:3072
    ds_read_b64_tr_b16 v[40:41], v7 offset:4096
    ds_read_b64_tr_b16 v[42:43], v7 offset:5120
    ds_read_b64_tr_b16 v[44:45], v7 offset:6144
    ds_read_b64_tr_b16 v[46:47], v7 offset:7168
    ds_read_b64_tr_b16 v[48:49], v7 offset:8192
    ds_read_b64_tr_b16 v[50:51], v7 offset:9216
    ds_read_b64_tr_b16 v[52:53], v7 offset:10240
    ds_read_b64_tr_b16 v[54:55], v7 offset:11264
    ds_read_b64_tr_b16 v[56:57], v7 offset:12288
    ds_read_b64_tr_b16 v[58:59], v7 offset:13312
    ds_read_b64_tr_b16 v[60:61], v7 offset:14336
    ds_read_b64_tr_b16 v[62:63], v7 offset:15360
    s_lshl_b32 s70, s47, 13
    s_lshl_b32 s71, s49, 7
    s_lshl_b32 s72, s3, 4
    s_add_u32 s78, s30, 0xc8000
    s_addc_u32 s79, s31, 0
    s_add_u32 s78, s78, s70
    s_addc_u32 s79, s79, 0
    s_add_u32 s78, s78, s71
    s_addc_u32 s79, s79, 0
    s_add_u32 s76, s30, 0xc4000
    s_addc_u32 s77, s31, 0
    s_add_u32 s76, s76, s70
    s_addc_u32 s77, s77, 0
    v_min_u32 v19, 55, v0
    v_lshlrev_b32 v19, 7, v19
    v_mov_b32 v29, v19
    s_mov_b32 s55, 0
    global_load_dwordx4 v[8:11], v29, s[76:77] sc1
Qx_30:
    global_load_dwordx4 v[12:15], v29, s[76:77] sc1
    s_waitcnt vmcnt(1)
    v_max3_u32 v31, v8, v9, v10
    v_max_u32 v31, v31, v11
    v_cmp_eq_u32 vcc, -1, v31
    s_cbranch_vccz Qxa_31
    global_load_dwordx4 v[8:11], v29, s[76:77] sc1
    s_waitcnt vmcnt(1)
    v_max3_u32 v31, v12, v13, v14
    v_max_u32 v31, v31, v15
    v_cmp_eq_u32 vcc, -1, v31
    s_cbranch_vccz Qxb_32
    s_add_u32 s55, s55, 1
    s_cmp_lt_u32 s55, 262144
    s_cbranch_scc1 Qx_30
    s_waitcnt vmcnt(0)
Qxa_31:
    v_mov_b32 v16, v8
    v_mov_b32 v17, v9
    v_mov_b32 v18, v10
    v_mov_b32 v19, v11
    s_branch Qxd_33
Qxb_32:
    v_mov_b32 v16, v12
    v_mov_b32 v17, v13
    v_mov_b32 v18, v14
    v_mov_b32 v19, v15
Qxd_33:
    v_cmp_gt_u32 vcc, 56, v0
    v_lshlrev_b32 v20, 16, v16
    v_and_b32 v21, 0xffff0000, v16
    v_lshlrev_b32 v22, 16, v17
    v_and_b32 v23, 0xffff0000, v17
    v_lshlrev_b32 v24, 16, v18
    v_and_b32 v25, 0xffff0000, v18
    v_lshlrev_b32 v26, 16, v19
    v_and_b32 v27, 0xffff0000, v19
    v_pk_add_f32 v[28:29], v[20:21], v[22:23]
    v_pk_mul_f32 v[30:31], v[20:21], v[20:21]
    v_pk_add_f32 v[16:17], v[24:25], v[26:27]
    v_pk_fma_f32 v[30:31], v[22:23], v[22:23], v[30:31]
    v_pk_add_f32 v[28:29], v[28:29], v[16:17]
    v_pk_fma_f32 v[30:31], v[24:25], v[24:25], v[30:31]
    v_add_f32 v28, v28, v29
    v_pk_fma_f32 v[30:31], v[26:27], v[26:27], v[30:31]
    v_cndmask_b32 v28, 0, v28, vcc
    v_add_f32 v30, v30, v31
    v_cndmask_b32 v30, 0, v30, vcc
    s_nop 0
    v_add_f32_dpp v28, v28, v28 row_ror:8 row_mask:0xf bank_mask:0xf
    v_add_f32_dpp v30, v30, v30 row_ror:8 row_mask:0xf bank_mask:0xf
    s_nop 0
    v_add_f32_dpp v28, v28, v28 row_ror:4 row_mask:0xf bank_mask:0xf
    v_add_f32_dpp v30, v30, v30 row_ror:4 row_mask:0xf bank_mask:0xf
    s_nop 0
    v_add_f32_dpp v28, v28, v28 row_ror:2 row_mask:0xf bank_mask:0xf
    v_add_f32_dpp v30, v30, v30 row_ror:2 row_mask:0xf bank_mask:0xf
    s_nop 0
    v_add_f32_dpp v28, v28, v28 row_ror:1 row_mask:0xf bank_mask:0xf
    v_add_f32_dpp v30, v30, v30 row_ror:1 row_mask:0xf bank_mask:0xf
    v_mov_b32 v29, v28
    v_mov_b32 v31, v30
    s_nop 0
    v_permlane16_swap_b32 v28, v29
    v_permlane16_swap_b32 v30, v31
    v_add_f32 v28, v28, v29
    v_add_f32 v30, v30, v31
    v_mov_b32 v29, v28
    v_mov_b32 v31, v30
    s_nop 0
    v_permlane32_swap_b32 v28, v29
    v_permlane32_swap_b32 v30, v31
    v_add_f32 v28, v28, v29
    v_add_f32 v30, v30, v31
    v_mul_f32 v28, 0x3b124925, v28
    v_mul_f32 v30, 0x3b124925, v30
    v_cvt_pk_bf16_f32 v29, v28, v28
    v_fma_f32 v30, -v28, v28, v30
    v_and_b32 v28, 0xffff0000, v29
    v_max_f32 v30, 0, v30
    v_cvt_pk_bf16_f32 v31, v30, v30
    v_pk_add_f32 v[20:21], v[20:21], v[28:29] op_sel_hi:[1,0] neg_lo:[0,1] neg_hi:[0,1]
    v_and_b32 v30, 0xffff0000, v31
    v_pk_add_f32 v[22:23], v[22:23], v[28:29] op_sel_hi:[1,0] neg_lo:[0,1] neg_hi:[0,1]
    v_add_f32 v30, 0x3727c5ac, v30
    v_pk_add_f32 v[24:25], v[24:25], v[28:29] op_sel_hi:[1,0] neg_lo:[0,1] neg_hi:[0,1]
    v_cvt_pk_bf16_f32 v31, v30, v30
    v_pk_add_f32 v[26:27], v[26:27], v[28:29] op_sel_hi:[1,0] neg_lo:[0,1] neg_hi:[0,1]
    v_and_b32 v30, 0xffff0000, v31
    v_cvt_pk_bf16_f32 v16, v20, v21
    v_sqrt_f32 v30, v30
    v_cvt_pk_bf16_f32 v17, v22, v23
    v_cvt_pk_bf16_f32 v18, v24, v25
    v_cvt_pk_bf16_f32 v31, v30, v30
    v_cvt_pk_bf16_f32 v19, v26, v27
    v_and_b32 v30, 0xffff0000, v31
    v_lshlrev_b32 v20, 16, v16
    v_rcp_f32 v30, v30
    v_and_b32 v21, 0xffff0000, v16
    v_lshlrev_b32 v22, 16, v17
    v_and_b32 v23, 0xffff0000, v17
    v_lshlrev_b32 v24, 16, v18
    v_and_b32 v25, 0xffff0000, v18
    v_lshlrev_b32 v26, 16, v19
    v_and_b32 v27, 0xffff0000, v19
    v_pk_mul_f32 v[20:21], v[20:21], v[30:31] op_sel_hi:[1,0]
    v_pk_mul_f32 v[22:23], v[22:23], v[30:31] op_sel_hi:[1,0]
    v_pk_mul_f32 v[24:25], v[24:25], v[30:31] op_sel_hi:[1,0]
    v_pk_mul_f32 v[26:27], v[26:27], v[30:31] op_sel_hi:[1,0]
    v_cvt_pk_bf16_f32 v16, v20, v21
    v_cvt_pk_bf16_f32 v17, v22, v23
    v_cvt_pk_bf16_f32 v18, v24, v25
    v_cvt_pk_bf16_f32 v19, v26, v27
    ds_write_b128 v5, v[16:19]
    s_waitcnt lgkmcnt(0)
    ds_read2_b64 v[20:23], v6 offset0:0 offset1:4
    ds_read2_b64 v[24:27], v6 offset0:8 offset1:12
    ds_read2_b64 v[28:31], v6 offset0:16 offset1:20
    s_waitcnt lgkmcnt(2)
    v_mfma_f32_16x16x32_bf16 v[16:19], v[20:23], v[32:35], 0
    ds_read2_b64 v[20:23], v6 offset0:24 offset1:28
    ds_read_b64_tr_b16 v[32:33], v7 offset:16384
    ds_read_b64_tr_b16 v[34:35], v7 offset:17408
    s_waitcnt lgkmcnt(4)
    v_mfma_f32_16x16x32_bf16 v[16:19], v[24:27], v[36:39], v[16:19]
    ds_read2_b64 v[24:27], v6 offset0:32 offset1:36
    ds_read_b64_tr_b16 v[36:37], v7 offset:18432
    ds_read_b64_tr_b16 v[38:39], v7 offset:19456
    s_waitcnt lgkmcnt(6)
    v_mfma_f32_16x16x32_bf16 v[16:19], v[28:31], v[40:43], v[16:19]
    ds_read2_b64 v[28:31], v6 offset0:40 offset1:44
    ds_read_b64_tr_b16 v[40:41], v7 offset:20480
    ds_read_b64_tr_b16 v[42:43], v7 offset:21504
    s_waitcnt lgkmcnt(8)
    v_mfma_f32_16x16x32_bf16 v[16:19], v[20:23], v[44:47], v[16:19]
    ds_read2_b64 v[20:23], v6 offset0:48 offset1:52
    ds_read_b64_tr_b16 v[44:45], v7 offset:22528
    ds_read_b64_tr_b16 v[46:47], v7 offset:23552
    s_waitcnt lgkmcnt(8)
    v_mfma_f32_16x16x32_bf16 v[16:19], v[24:27], v[48:51], v[16:19]
    ds_read2_b64 v[24:27], v6 offset0:56 offset1:60
    ds_read_b64_tr_b16 v[48:49], v7 offset:24576
    ds_read_b64_tr_b16 v[50:51], v7 offset:25600
    s_waitcnt lgkmcnt(8)
    v_mfma_f32_16x16x32_bf16 v[16:19], v[28:31], v[52:55], v[16:19]
    ds_read2_b64 v[28:31], v6 offset0:64 offset1:68
    ds_read_b64_tr_b16 v[52:53], v7 offset:26624
    ds_read_b64_tr_b16 v[54:55], v7 offset:27648
    s_waitcnt lgkmcnt(8)
    v_mfma_f32_16x16x32_bf16 v[16:19], v[20:23], v[56:59], v[16:19]
    ds_read2_b64 v[20:23], v6 offset0:72 offset1:76
    s_waitcnt lgkmcnt(6)
    v_mfma_f32_16x16x32_bf16 v[16:19], v[24:27], v[60:63], v[16:19]
    ds_read2_b64 v[24:27], v6 offset0:80 offset1:84
    s_waitcnt lgkmcnt(4)
    v_mfma_f32_16x16x32_bf16 v[16:19], v[28:31], v[32:35], v[16:19]
    ds_read2_b64 v[28:31], v6 offset0:88 offset1:92
    s_waitcnt lgkmcnt(2)
    v_mfma_f32_16x16x32_bf16 v[16:19], v[20:23], v[36:39], v[16:19]
    ds_read2_b64 v[20:23], v6 offset0:96 offset1:100
    s_waitcnt lgkmcnt(2)
    v_mfma_f32_16x16x32_bf16 v[16:19], v[24:27], v[40:43], v[16:19]
    ds_read2_b64 v[24:27], v6 offset0:104 offset1:108
    s_waitcnt lgkmcnt(2)
    v_mfma_f32_16x16x32_bf16 v[16:19], v[28:31], v[44:47], v[16:19]
    s_waitcnt lgkmcnt(1)
    v_mfma_f32_16x16x32_bf16 v[16:19], v[20:23], v[48:51], v[16:19]
    s_waitcnt lgkmcnt(0)
    v_mfma_f32_16x16x32_bf16 v[16:19], v[24:27], v[52:55], v[16:19]
    s_nop 7
    v_cvt_pk_bf16_f32 v17, v16, v16
    v_and_b32 v16, 0xffff0000, v17
    v_mul_f32 v19, 0xbfb8aa3b, v16
    v_exp_f32 v19, v19
    v_mov_b32_dpp v18, v16 row_ror:8 row_mask:0xf bank_mask:0xf
    v_add_f32 v19, 1.0, v19
    v_rcp_f32 v19, v19
    v_mov_b32 v27, -2
    v_mul_f32 v19, v16, v19
    v_cvt_pk_bf16_f32 v17, v19, v19
    v_and_b32 v19, 0xffff0000, v17
    v_mul_f32 v19, v19, v18
    s_nop 1
    v_mov_b32_dpp v25, v19 quad_perm:[1,0,3,2] row_mask:0xf bank_mask:0xf
    s_mul_i32 s70, s3, 16
    s_add_u32 s70, s70, 2752
    v_cvt_pk_bf16_f32 v25, v19, v25
    v_lshlrev_b32 v26, 1, v0
    v_add_u32 v26, s70, v26
    v_min_u32 v25, v25, v27
    s_mov_b64 exec, 0x55
    ds_write_b32 v26, v25
    s_mov_b64 exec, -1
    v_lshlrev_b32 v26, 2, v0
    s_waitcnt lgkmcnt(0)
    s_barrier
    s_cmp_eq_u32 s3, 0
    s_cbranch_scc0 Lpw_34
    ds_read_b32 v25, v26 offset:2752
    s_mov_b64 exec, 0xffff
    s_waitcnt lgkmcnt(0)
    global_store_dword v26, v25, s[78:79] sc1
    s_mov_b64 exec, -1
Lpw_34:
    s_cmp_eq_u32 s3, 0
    s_cbranch_scc1 Lwl_35
    s_waitcnt vmcnt(0)
    s_branch Lwl_36
Lwl_35:
    s_waitcnt vmcnt(1)
Lwl_36:
    s_cmp_eq_u32 s47, 0
    s_cbranch_scc0 Tud_38
    s_sub_u32 s75, s52, 2
Tu_37:
    s_waitcnt vmcnt(0)
    s_call_b64 s[66:67], L_issue
    s_sub_u32 s75, s75, 1
    s_cmp_lg_u32 s75, 0
    s_cbranch_scc1 Tu_37
Tud_38:
    s_branch L_next
L_roleC:
    s_waitcnt vmcnt(0)
    v_lshrrev_b32 v28, 4, v0
    v_bfe_u32 v29, v0, 2, 2
    v_and_b32 v30, 3, v0
    v_lshlrev_b32 v6, 3, v28
    v_add_u32 v6, s53, v6
    v_lshlrev_b32 v5, 4, v0
    v_add_u32 v5, s53, v5
    v_lshl_add_u32 v7, v28, 2, v29
    s_mul_i32 s70, s3, 14336
    s_add_u32 s70, s70, 7168
    v_lshlrev_b32 v7, 5, v7
    v_lshl_add_u32 v7, v30, 3, v7
    v_add_u32 v7, s70, v7
    ds_read_b64_tr_b16 v[32:33], v7 offset:0
    ds_read_b64_tr_b16 v[34:35], v7 offset:512
    ds_read_b64_tr_b16 v[36:37], v7 offset:1024
    ds_read_b64_tr_b16 v[38:39], v7 offset:1536
    ds_read_b64_tr_b16 v[40:41], v7 offset:2048
    ds_read_b64_tr_b16 v[42:43], v7 offset:2560
    ds_read_b64_tr_b16 v[44:45], v7 offset:3072
    ds_read_b64_tr_b16 v[46:47], v7 offset:3584
    ds_read_b64_tr_b16 v[48:49], v7 offset:4096
    ds_read_b64_tr_b16 v[50:51], v7 offset:4608
    ds_read_b64_tr_b16 v[52:53], v7 offset:5120
    ds_read_b64_tr_b16 v[54:55], v7 offset:5632
    ds_read_b64_tr_b16 v[56:57], v7 offset:6144
    ds_read_b64_tr_b16 v[58:59], v7 offset:6656
    ds_read_b64_tr_b16 v[60:61], v7 offset:7168
    ds_read_b64_tr_b16 v[62:63], v7 offset:7680
    s_lshl_b32 s70, s47, 13
    s_lshl_b32 s71, s49, 8
    s_add_u32 s78, s30, 0xc4000
    s_addc_u32 s79, s31, 0
    s_add_u32 s78, s78, s70
    s_addc_u32 s79, s79, 0
    s_add_u32 s78, s78, s71
    s_addc_u32 s79, s79, 0
    v_bfe_u32 v20, v0, 3, 1
    v_lshlrev_b32 v20, 7, v20
    v_bfe_u32 v21, v0, 1, 2
    v_lshl_add_u32 v20, v21, 2, v20
    s_mov_b32 s55, 0
Pr_39:
    global_load_dword v22, v20, s[78:79] sc1
    s_waitcnt vmcnt(0)
    v_cmp_eq_u32 vcc, -1, v22
    s_cbranch_vccz Prd_40
    s_add_u32 s55, s55, 1
    s_cmp_lt_u32 s55, 262144
    s_cbranch_scc1 Pr_39
Prd_40:
    v_and_b32 v23, 1, v0
    v_cmp_eq_u32 vcc, 1, v23
    v_lshlrev_b32 v23, 16, v22
    v_and_b32 v22, 0xffff0000, v22
    v_cndmask_b32 v22, v23, v22, vcc
    v_and_b32 v23, 15, v0
    v_lshlrev_b32 v23, 2, v23
    ds_write_b32 v23, v22 offset:3008
    s_lshl_b32 s70, s47, 13
    s_mul_i32 s71, s3, 1792
    s_add_u32 s76, s30, 0xc8000
    s_addc_u32 s77, s31, 0
    s_add_u32 s76, s76, s70
    s_addc_u32 s77, s77, 0
    s_add_u32 s76, s76, s71
    s_addc_u32 s77, s77, 0
    v_min_u32 v29, 55, v0
    v_and_b32 v28, 3, v29
    v_lshrrev_b32 v29, 2, v29
    v_lshlrev_b32 v29, 7, v29
    v_lshl_add_u32 v29, v28, 4, v29
    s_cmp_eq_u32 s47, 0
    s_lshl_b32 s71, s49, 7
    s_lshl_b32 s72, s49, 5
    s_cmp_eq_u32 s47, 0
    s_cbranch_scc0 Lco_41
    s_add_u32 s78, s30, 0xcc000
    s_addc_u32 s79, s31, 0
    s_add_u32 s78, s78, s71
    s_addc_u32 s79, s79, 0
    s_branch Lcod_42
Lco_41:
    s_add_u32 s78, s26, 0
    s_addc_u32 s79, s27, 0
    s_add_u32 s78, s78, s72
    s_addc_u32 s79, s79, 0
Lcod_42:
    s_mov_b32 s55, 0
    global_load_dwordx4 v[8:11], v29, s[76:77] sc1
Qh_43:
    global_load_dwordx4 v[12:15], v29, s[76:77] sc1
    s_waitcnt vmcnt(1)
    v_max3_u32 v31, v8, v9, v10
    v_max_u32 v31, v31, v11
    v_cmp_eq_u32 vcc, -1, v31
    s_cbranch_vccz Qha_44
    global_load_dwordx4 v[8:11], v29, s[76:77] sc1
    s_waitcnt vmcnt(1)
    v_max3_u32 v31, v12, v13, v14
    v_max_u32 v31, v31, v15
    v_cmp_eq_u32 vcc, -1, v31
    s_cbranch_vccz Qhb_45
    s_add_u32 s55, s55, 1
    s_cmp_lt_u32 s55, 262144
    s_cbranch_scc1 Qh_43
    s_waitcnt vmcnt(0)
Qha_44:
    v_mov_b32 v16, v8
    v_mov_b32 v17, v9
    v_mov_b32 v18, v10
    v_mov_b32 v19, v11
    s_branch Qhd_46
Qhb_45:
    v_mov_b32 v16, v12
    v_mov_b32 v17, v13
    v_mov_b32 v18, v14
    v_mov_b32 v19, v15
Qhd_46:
    ds_write_b128 v5, v[16:19]
    s_waitcnt lgkmcnt(0)
    ds_read2_b64 v[20:23], v6 offset0:0 offset1:4
    ds_read2_b64 v[24:27], v6 offset0:8 offset1:12
    ds_read2_b64 v[28:31], v6 offset0:16 offset1:20
    s_waitcnt lgkmcnt(2)
    v_mfma_f32_16x16x32_bf16 v[16:19], v[20:23], v[32:35], 0
    ds_read2_b64 v[20:23], v6 offset0:24 offset1:28
    ds_read_b64_tr_b16 v[32:33], v7 offset:8192
    ds_read_b64_tr_b16 v[34:35], v7 offset:8704
    s_waitcnt lgkmcnt(4)
    v_mfma_f32_16x16x32_bf16 v[16:19], v[24:27], v[36:39], v[16:19]
    ds_read2_b64 v[24:27], v6 offset0:32 offset1:36
    ds_read_b64_tr_b16 v[36:37], v7 offset:9216
    ds_read_b64_tr_b16 v[38:39], v7 offset:9728
    s_waitcnt lgkmcnt(6)
    v_mfma_f32_16x16x32_bf16 v[16:19], v[28:31], v[40:43], v[16:19]
    ds_read2_b64 v[28:31], v6 offset0:40 offset1:44
    ds_read_b64_tr_b16 v[40:41], v7 offset:10240
    ds_read_b64_tr_b16 v[42:43], v7 offset:10752
    s_waitcnt lgkmcnt(8)
    v_mfma_f32_16x16x32_bf16 v[16:19], v[20:23], v[44:47], v[16:19]
    ds_read2_b64 v[20:23], v6 offset0:48 offset1:52
    ds_read_b64_tr_b16 v[44:45], v7 offset:11264
    ds_read_b64_tr_b16 v[46:47], v7 offset:11776
    s_waitcnt lgkmcnt(8)
    v_mfma_f32_16x16x32_bf16 v[16:19], v[24:27], v[48:51], v[16:19]
    ds_read2_b64 v[24:27], v6 offset0:56 offset1:60
    ds_read_b64_tr_b16 v[48:49], v7 offset:12288
    ds_read_b64_tr_b16 v[50:51], v7 offset:12800
    s_waitcnt lgkmcnt(8)
    v_mfma_f32_16x16x32_bf16 v[16:19], v[28:31], v[52:55], v[16:19]
    ds_read2_b64 v[28:31], v6 offset0:64 offset1:68
    ds_read_b64_tr_b16 v[52:53], v7 offset:13312
    ds_read_b64_tr_b16 v[54:55], v7 offset:13824
    s_waitcnt lgkmcnt(8)
    v_mfma_f32_16x16x32_bf16 v[16:19], v[20:23], v[56:59], v[16:19]
    ds_read2_b64 v[20:23], v6 offset0:72 offset1:76
    s_waitcnt lgkmcnt(6)
    v_mfma_f32_16x16x32_bf16 v[16:19], v[24:27], v[60:63], v[16:19]
    ds_read2_b64 v[24:27], v6 offset0:80 offset1:84
    s_waitcnt lgkmcnt(4)
    v_mfma_f32_16x16x32_bf16 v[16:19], v[28:31], v[32:35], v[16:19]
    ds_read2_b64 v[28:31], v6 offset0:88 offset1:92
    s_waitcnt lgkmcnt(2)
    v_mfma_f32_16x16x32_bf16 v[16:19], v[20:23], v[36:39], v[16:19]
    ds_read2_b64 v[20:23], v6 offset0:96 offset1:100
    s_waitcnt lgkmcnt(2)
    v_mfma_f32_16x16x32_bf16 v[16:19], v[24:27], v[40:43], v[16:19]
    ds_read2_b64 v[24:27], v6 offset0:104 offset1:108
    s_waitcnt lgkmcnt(2)
    v_mfma_f32_16x16x32_bf16 v[16:19], v[28:31], v[44:47], v[16:19]
    s_waitcnt lgkmcnt(1)
    v_mfma_f32_16x16x32_bf16 v[16:19], v[20:23], v[48:51], v[16:19]
    s_waitcnt lgkmcnt(0)
    v_mfma_f32_16x16x32_bf16 v[16:19], v[24:27], v[52:55], v[16:19]
    s_nop 7
    v_and_b32 v20, 15, v0
    v_lshlrev_b32 v20, 2, v20
    s_lshl_b32 s70, s3, 6
    s_add_u32 s70, s70, 2752
    v_add_u32 v21, s70, v20
    ds_write_b32 v21, v16
    s_waitcnt lgkmcnt(0)
    s_barrier
    s_cmp_eq_u32 s3, 0
    s_cbranch_scc0 Lcz_47
    ds_read_b32 v22, v20 offset:2752
    ds_read_b32 v23, v20 offset:2816
    ds_read_b32 v24, v20 offset:2880
    ds_read_b32 v25, v20 offset:2944
    ds_read_b32 v21, v20 offset:3008
    v_mov_b32 v27, -2
    v_lshlrev_b32 v26, 1, v0
    s_waitcnt lgkmcnt(0)
    v_add_f32 v22, v22, v23
    v_add_f32 v24, v24, v25
    v_add_f32 v16, v22, v24
    v_cvt_pk_bf16_f32 v17, v16, v16
    v_and_b32 v16, 0xffff0000, v17
    v_add_f32 v16, v16, v21
    s_nop 0
    v_mov_b32_dpp v25, v16 quad_perm:[1,0,3,2] row_mask:0xf bank_mask:0xf
    v_cvt_pk_bf16_f32 v25, v16, v25
    v_min_u32 v25, v25, v27
    s_mov_b64 exec, 0x5555
    global_store_dword v26, v25, s[78:79] sc1
    s_mov_b64 exec, -1
    s_waitcnt vmcnt(1)
    s_branch Lce_48
Lcz_47:
    s_waitcnt vmcnt(0)
Lce_48:
    s_cmp_eq_u32 s47, 0
    s_cbranch_scc0 Tud_50
    s_sub_u32 s75, s52, 2
Tu_49:
    s_call_b64 s[66:67], L_issue
    s_sub_u32 s75, s75, 1
    s_cmp_lg_u32 s75, 0
    s_cbranch_scc1 Tu_49
Tud_50:
    s_branch L_next
L_roleD:
    s_cmp_eq_u32 s3, 0
    s_cbranch_scc0 L_D_rdone
    s_cmp_lt_u32 s49, 56
    s_cbranch_scc0 L_D_rdone
    v_lshrrev_b32 v24, 4, v0
    v_lshlrev_b32 v24, 2, v24
    s_cmp_eq_u32 s47, 0
    s_cbranch_scc0 L_R_r1
    s_lshl_b32 s70, s49, 4
    s_add_u32 s78, s8, 0
    s_addc_u32 s79, s9, 0
    s_add_u32 s78, s78, s70
    s_addc_u32 s79, s79, 0
    s_branch L_R_r2
L_R_r1:
    s_lshr_b32 s70, s49, 1
    s_lshl_b32 s70, s70, 7
    s_and_b32 s71, s49, 1
    s_lshl_b32 s71, s71, 4
    s_add_u32 s78, s30, 0xcc000
    s_addc_u32 s79, s31, 0
    s_add_u32 s78, s78, s70
    s_addc_u32 s79, s79, 0
    s_add_u32 s78, s78, s71
    s_addc_u32 s79, s79, 0
L_R_r2:
    global_load_dword v25, v24, s[78:79] sc1
    s_lshl_b32 s70, s47, 13
    s_lshl_b32 s71, s49, 7
    s_add_u32 s78, s30, 0xc4000
    s_addc_u32 s79, s31, 0
    s_add_u32 s78, s78, s70
    s_addc_u32 s79, s79, 0
    s_add_u32 s78, s78, s71
    s_addc_u32 s79, s79, 0
    s_mul_i32 s72, s49, 4682
    s_lshr_b32 s72, s72, 16
    s_mul_i32 s73, s72, 14
    s_sub_u32 s73, s49, s73
    s_lshl_b32 s72, s72, 9
    s_lshl_b32 s73, s73, 5
    s_add_u32 s70, s72, s73
    s_mul_i32 s71, s47, 0x20000
    s_add_u32 s76, s30, 0x100000
    s_addc_u32 s77, s31, 0
    s_add_u32 s76, s76, s70
    s_addc_u32 s77, s77, 0
    s_add_u32 s76, s76, s71
    s_addc_u32 s77, s77, 0
    v_mul_u32_u24 v29, 2048, v0
    v_mov_b32 v41, -2
    s_mov_b32 s55, 0
    global_load_dwordx4 v[8:11], v29, s[76:77] sc1
    global_load_dwordx4 v[12:15], v29, s[76:77] offset:16 sc1
Qr_51:
    global_load_dwordx4 v[16:19], v29, s[76:77] sc1
    global_load_dwordx4 v[20:23], v29, s[76:77] offset:16 sc1
    s_waitcnt vmcnt(2)
    v_max3_u32 v31, v8, v9, v10
    v_max3_u32 v31, v31, v11, v12
    v_max3_u32 v31, v31, v13, v14
    v_max_u32 v31, v31, v15
    v_cmp_eq_u32 vcc, -1, v31
    s_cbranch_vccz Qra_52
    global_load_dwordx4 v[8:11], v29, s[76:77] sc1
    global_load_dwordx4 v[12:15], v29, s[76:77] offset:16 sc1
    s_waitcnt vmcnt(2)
    v_max3_u32 v31, v16, v17, v18
    v_max3_u32 v31, v31, v19, v20
    v_max3_u32 v31, v31, v21, v22
    v_max_u32 v31, v31, v23
    v_cmp_eq_u32 vcc, -1, v31
    s_cbranch_vccz Qrb_53
    s_add_u32 s55, s55, 1
    s_cmp_lt_u32 s55, 262144
    s_cbranch_scc1 Qr_51
    s_waitcnt vmcnt(0)
Qra_52:
    v_mov_b32 v32, v8
    v_mov_b32 v33, v9
    v_mov_b32 v34, v10
    v_mov_b32 v35, v11
    v_mov_b32 v36, v12
    v_mov_b32 v37, v13
    v_mov_b32 v38, v14
    v_mov_b32 v39, v15
    s_branch Qrd_54
Qrb_53:
    v_mov_b32 v32, v16
    v_mov_b32 v33, v17
    v_mov_b32 v34, v18
    v_mov_b32 v35, v19
    v_mov_b32 v36, v20
    v_mov_b32 v37, v21
    v_mov_b32 v38, v22
    v_mov_b32 v39, v23
Qrd_54:
    s_nop 0
    v_permlane32_swap_b32 v32, v36
    v_permlane32_swap_b32 v33, v37
    v_permlane32_swap_b32 v34, v38
    v_permlane32_swap_b32 v35, v39
    v_pk_add_f32 v[32:33], v[32:33], v[36:37]
    v_pk_add_f32 v[34:35], v[34:35], v[38:39]
    s_nop 1
    v_permlane16_swap_b32 v32, v34
    v_permlane16_swap_b32 v33, v35
    v_pk_add_f32 v[32:33], v[32:33], v[34:35]
    s_nop 0
    s_nop 0
    v_add_f32_dpp v32, v32, v32 row_ror:8 row_mask:0xf bank_mask:0xf
    v_add_f32_dpp v33, v33, v33 row_ror:8 row_mask:0xf bank_mask:0xf
    s_nop 0
    v_add_f32_dpp v32, v32, v32 row_ror:4 row_mask:0xf bank_mask:0xf
    v_add_f32_dpp v33, v33, v33 row_ror:4 row_mask:0xf bank_mask:0xf
    s_nop 0
    v_add_f32_dpp v32, v32, v32 row_ror:2 row_mask:0xf bank_mask:0xf
    v_add_f32_dpp v33, v33, v33 row_ror:2 row_mask:0xf bank_mask:0xf
    s_nop 0
    v_add_f32_dpp v32, v32, v32 row_ror:1 row_mask:0xf bank_mask:0xf
    v_add_f32_dpp v33, v33, v33 row_ror:1 row_mask:0xf bank_mask:0xf
    v_cvt_pk_bf16_f32 v34, v32, v33
    v_lshlrev_b32 v35, 16, v25
    v_and_b32 v36, 0xffff0000, v25
    v_lshlrev_b32 v32, 16, v34
    v_and_b32 v33, 0xffff0000, v34
    v_add_f32 v32, v32, v35
    v_add_f32 v33, v33, v36
    v_cvt_pk_bf16_f32 v34, v32, v33
    v_min_u32 v34, v34, v41
    s_mov_b32 exec_lo, 0x00010001
    s_mov_b32 exec_hi, 0x00010001
    global_store_dword v24, v34, s[78:79] sc1
    s_mov_b64 exec, -1
    s_waitcnt vmcnt(1)
L_D_rdone:
    s_cmp_eq_u32 s47, 0
    s_cbranch_scc0 Tud_56
    s_sub_u32 s75, s52, 2
Tu_55:
    s_waitcnt vmcnt(0)
    s_call_b64 s[66:67], L_issue
    s_sub_u32 s75, s75, 1
    s_cmp_lg_u32 s75, 0
    s_cbranch_scc1 Tu_55
Tud_56:
    s_cmp_eq_u32 s47, 0
    s_cbranch_scc0 L_next
    s_call_b64 s[88:89], L_stageD_prep
    s_add_u32 s76, s30, 0xcc000
    s_addc_u32 s77, s31, 0
    v_min_u32 v19, 55, v0
    v_and_b32 v18, 1, v19
    v_lshrrev_b32 v19, 1, v19
    v_lshlrev_b32 v19, 7, v19
    v_lshl_add_u32 v19, v18, 4, v19
    v_mov_b32 v29, v19
    s_mov_b32 s55, 0
    global_load_dwordx4 v[8:11], v29, s[76:77] sc1
Qx_57:
    global_load_dwordx4 v[12:15], v29, s[76:77] sc1
    s_waitcnt vmcnt(1)
    v_max3_u32 v31, v8, v9, v10
    v_max_u32 v31, v31, v11
    v_cmp_eq_u32 vcc, -1, v31
    s_cbranch_vccz Qxa_58
    global_load_dwordx4 v[8:11], v29, s[76:77] sc1
    s_waitcnt vmcnt(1)
    v_max3_u32 v31, v12, v13, v14
    v_max_u32 v31, v31, v15
    v_cmp_eq_u32 vcc, -1, v31
    s_cbranch_vccz Qxb_59
    s_add_u32 s55, s55, 1
    s_cmp_lt_u32 s55, 262144
    s_cbranch_scc1 Qx_57
    s_waitcnt vmcnt(0)
Qxa_58:
    v_mov_b32 v16, v8
    v_mov_b32 v17, v9
    v_mov_b32 v18, v10
    v_mov_b32 v19, v11
    s_branch Qxd_60
Qxb_59:
    v_mov_b32 v16, v12
    v_mov_b32 v17, v13
    v_mov_b32 v18, v14
    v_mov_b32 v19, v15
Qxd_60:
    s_lshl_b32 s70, s49, 7
    s_lshl_b32 s71, s3, 5
    s_add_u32 s78, s30, 0xd0000
    s_addc_u32 s79, s31, 0
    s_add_u32 s78, s78, s70
    s_addc_u32 s79, s79, 0
    s_call_b64 s[88:89], L_stageD_rest
    s_cmp_eq_u32 s3, 0
    s_cbranch_scc1 Lwl_61
    s_waitcnt vmcnt(0)
    s_branch Lwl_62
Lwl_61:
    s_waitcnt vmcnt(1)
Lwl_62:
L_next:
    s_add_u32 s47, s47, 1
    s_cmp_lt_u32 s47, 2
    s_cbranch_scc1 L_pass
    s_waitcnt vmcnt(0)
L_end:
    s_endpgm
L_stageD_prep:
    v_lshrrev_b32 v28, 4, v0
    v_bfe_u32 v29, v0, 2, 2
    v_and_b32 v30, 3, v0
    v_lshlrev_b32 v6, 3, v28
    v_add_u32 v6, s53, v6
    v_lshlrev_b32 v5, 4, v0
    v_add_u32 v5, s53, v5
    v_lshl_add_u32 v7, v28, 2, v29
    v_bfe_u32 v31, v7, 1, 2
    v_xor_b32 v31, s3, v31
    v_lshlrev_b32 v7, 7, v7
    v_lshl_add_u32 v7, v31, 5, v7
    v_lshl_add_u32 v7, v30, 3, v7
    v_add_u32 v7, 7168, v7
    ds_read_b64_tr_b16 v[32:33], v7 offset:0
    ds_read_b64_tr_b16 v[34:35], v7 offset:2048
    ds_read_b64_tr_b16 v[36:37], v7 offset:4096
    ds_read_b64_tr_b16 v[38:39], v7 offset:6144
    ds_read_b64_tr_b16 v[40:41], v7 offset:8192
    ds_read_b64_tr_b16 v[42:43], v7 offset:10240
    ds_read_b64_tr_b16 v[44:45], v7 offset:12288
    ds_read_b64_tr_b16 v[46:47], v7 offset:14336
    ds_read_b64_tr_b16 v[48:49], v7 offset:16384
    ds_read_b64_tr_b16 v[50:51], v7 offset:18432
    ds_read_b64_tr_b16 v[52:53], v7 offset:20480
    ds_read_b64_tr_b16 v[54:55], v7 offset:22528
    ds_read_b64_tr_b16 v[56:57], v7 offset:24576
    ds_read_b64_tr_b16 v[58:59], v7 offset:26624
    ds_read_b64_tr_b16 v[60:61], v7 offset:28672
    ds_read_b64_tr_b16 v[62:63], v7 offset:30720
    s_setpc_b64 s[88:89]
L_stageD_rest:
    v_cmp_gt_u32 vcc, 56, v0
    v_lshlrev_b32 v20, 16, v16
    v_and_b32 v21, 0xffff0000, v16
    v_lshlrev_b32 v22, 16, v17
    v_and_b32 v23, 0xffff0000, v17
    v_lshlrev_b32 v24, 16, v18
    v_and_b32 v25, 0xffff0000, v18
    v_lshlrev_b32 v26, 16, v19
    v_and_b32 v27, 0xffff0000, v19
    v_pk_add_f32 v[28:29], v[20:21], v[22:23]
    v_pk_mul_f32 v[30:31], v[20:21], v[20:21]
    v_pk_add_f32 v[16:17], v[24:25], v[26:27]
    v_pk_fma_f32 v[30:31], v[22:23], v[22:23], v[30:31]
    v_pk_add_f32 v[28:29], v[28:29], v[16:17]
    v_pk_fma_f32 v[30:31], v[24:25], v[24:25], v[30:31]
    v_add_f32 v28, v28, v29
    v_pk_fma_f32 v[30:31], v[26:27], v[26:27], v[30:31]
    v_cndmask_b32 v28, 0, v28, vcc
    v_add_f32 v30, v30, v31
    v_cndmask_b32 v30, 0, v30, vcc
    s_nop 0
    v_add_f32_dpp v28, v28, v28 row_ror:8 row_mask:0xf bank_mask:0xf
    v_add_f32_dpp v30, v30, v30 row_ror:8 row_mask:0xf bank_mask:0xf
    s_nop 0
    v_add_f32_dpp v28, v28, v28 row_ror:4 row_mask:0xf bank_mask:0xf
    v_add_f32_dpp v30, v30, v30 row_ror:4 row_mask:0xf bank_mask:0xf
    s_nop 0
    v_add_f32_dpp v28, v28, v28 row_ror:2 row_mask:0xf bank_mask:0xf
    v_add_f32_dpp v30, v30, v30 row_ror:2 row_mask:0xf bank_mask:0xf
    s_nop 0
    v_add_f32_dpp v28, v28, v28 row_ror:1 row_mask:0xf bank_mask:0xf
    v_add_f32_dpp v30, v30, v30 row_ror:1 row_mask:0xf bank_mask:0xf
    v_mov_b32 v29, v28
    v_mov_b32 v31, v30
    s_nop 0
    v_permlane16_swap_b32 v28, v29
    v_permlane16_swap_b32 v30, v31
    v_add_f32 v28, v28, v29
    v_add_f32 v30, v30, v31
    v_mov_b32 v29, v28
    v_mov_b32 v31, v30
    s_nop 0
    v_permlane32_swap_b32 v28, v29
    v_permlane32_swap_b32 v30, v31
    v_add_f32 v28, v28, v29
    v_add_f32 v30, v30, v31
    v_mul_f32 v28, 0x3b124925, v28
    v_mul_f32 v30, 0x3b124925, v30
    v_cvt_pk_bf16_f32 v29, v28, v28
    v_fma_f32 v30, -v28, v28, v30
    v_and_b32 v28, 0xffff0000, v29
    v_max_f32 v30, 0, v30
    v_cvt_pk_bf16_f32 v31, v30, v30
    v_pk_add_f32 v[20:21], v[20:21], v[28:29] op_sel_hi:[1,0] neg_lo:[0,1] neg_hi:[0,1]
    v_and_b32 v30, 0xffff0000, v31
    v_pk_add_f32 v[22:23], v[22:23], v[28:29] op_sel_hi:[1,0] neg_lo:[0,1] neg_hi:[0,1]
    v_add_f32 v30, 0x3727c5ac, v30
    v_pk_add_f32 v[24:25], v[24:25], v[28:29] op_sel_hi:[1,0] neg_lo:[0,1] neg_hi:[0,1]
    v_cvt_pk_bf16_f32 v31, v30, v30
    v_pk_add_f32 v[26:27], v[26:27], v[28:29] op_sel_hi:[1,0] neg_lo:[0,1] neg_hi:[0,1]
    v_and_b32 v30, 0xffff0000, v31
    v_cvt_pk_bf16_f32 v16, v20, v21
    v_sqrt_f32 v30, v30
    v_cvt_pk_bf16_f32 v17, v22, v23
    v_cvt_pk_bf16_f32 v18, v24, v25
    v_cvt_pk_bf16_f32 v31, v30, v30
    v_cvt_pk_bf16_f32 v19, v26, v27
    v_and_b32 v30, 0xffff0000, v31
    v_lshlrev_b32 v20, 16, v16
    v_rcp_f32 v30, v30
    v_and_b32 v21, 0xffff0000, v16
    v_lshlrev_b32 v22, 16, v17
    v_and_b32 v23, 0xffff0000, v17
    v_lshlrev_b32 v24, 16, v18
    v_and_b32 v25, 0xffff0000, v18
    v_lshlrev_b32 v26, 16, v19
    v_and_b32 v27, 0xffff0000, v19
    v_pk_mul_f32 v[20:21], v[20:21], v[30:31] op_sel_hi:[1,0]
    v_pk_mul_f32 v[22:23], v[22:23], v[30:31] op_sel_hi:[1,0]
    v_pk_mul_f32 v[24:25], v[24:25], v[30:31] op_sel_hi:[1,0]
    v_pk_mul_f32 v[26:27], v[26:27], v[30:31] op_sel_hi:[1,0]
    v_cvt_pk_bf16_f32 v16, v20, v21
    v_cvt_pk_bf16_f32 v17, v22, v23
    v_cvt_pk_bf16_f32 v18, v24, v25
    v_cvt_pk_bf16_f32 v19, v26, v27
    ds_write_b128 v5, v[16:19]
    s_waitcnt lgkmcnt(0)
    ds_read2_b64 v[20:23], v6 offset0:0 offset1:4
    ds_read2_b64 v[24:27], v6 offset0:8 offset1:12
    ds_read2_b64 v[28:31], v6 offset0:16 offset1:20
    s_waitcnt lgkmcnt(2)
    v_mfma_f32_16x16x32_bf16 v[16:19], v[20:23], v[32:35], 0
    ds_read2_b64 v[20:23], v6 offset0:24 offset1:28
    ds_read_b64_tr_b16 v[32:33], v7 offset:32768
    ds_read_b64_tr_b16 v[34:35], v7 offset:34816
    s_waitcnt lgkmcnt(4)
    v_mfma_f32_16x16x32_bf16 v[16:19], v[24:27], v[36:39], v[16:19]
    ds_read2_b64 v[24:27], v6 offset0:32 offset1:36
    ds_read_b64_tr_b16 v[36:37], v7 offset:36864
    ds_read_b64_tr_b16 v[38:39], v7 offset:38912
    s_waitcnt lgkmcnt(6)
    v_mfma_f32_16x16x32_bf16 v[16:19], v[28:31], v[40:43], v[16:19]
    ds_read2_b64 v[28:31], v6 offset0:40 offset1:44
    ds_read_b64_tr_b16 v[40:41], v7 offset:40960
    ds_read_b64_tr_b16 v[42:43], v7 offset:43008
    s_waitcnt lgkmcnt(8)
    v_mfma_f32_16x16x32_bf16 v[16:19], v[20:23], v[44:47], v[16:19]
    ds_read2_b64 v[20:23], v6 offset0:48 offset1:52
    ds_read_b64_tr_b16 v[44:45], v7 offset:45056
    ds_read_b64_tr_b16 v[46:47], v7 offset:47104
    s_waitcnt lgkmcnt(8)
    v_mfma_f32_16x16x32_bf16 v[16:19], v[24:27], v[48:51], v[16:19]
    ds_read2_b64 v[24:27], v6 offset0:56 offset1:60
    ds_read_b64_tr_b16 v[48:49], v7 offset:49152
    ds_read_b64_tr_b16 v[50:51], v7 offset:51200
    s_waitcnt lgkmcnt(8)
    v_mfma_f32_16x16x32_bf16 v[16:19], v[28:31], v[52:55], v[16:19]
    ds_read2_b64 v[28:31], v6 offset0:64 offset1:68
    ds_read_b64_tr_b16 v[52:53], v7 offset:53248
    ds_read_b64_tr_b16 v[54:55], v7 offset:55296
    s_waitcnt lgkmcnt(8)
    v_mfma_f32_16x16x32_bf16 v[16:19], v[20:23], v[56:59], v[16:19]
    ds_read2_b64 v[20:23], v6 offset0:72 offset1:76
    s_waitcnt lgkmcnt(6)
    v_mfma_f32_16x16x32_bf16 v[16:19], v[24:27], v[60:63], v[16:19]
    ds_read2_b64 v[24:27], v6 offset0:80 offset1:84
    s_waitcnt lgkmcnt(4)
    v_mfma_f32_16x16x32_bf16 v[16:19], v[28:31], v[32:35], v[16:19]
    ds_read2_b64 v[28:31], v6 offset0:88 offset1:92
    s_waitcnt lgkmcnt(2)
    v_mfma_f32_16x16x32_bf16 v[16:19], v[20:23], v[36:39], v[16:19]
    ds_read2_b64 v[20:23], v6 offset0:96 offset1:100
    s_waitcnt lgkmcnt(2)
    v_mfma_f32_16x16x32_bf16 v[16:19], v[24:27], v[40:43], v[16:19]
    ds_read2_b64 v[24:27], v6 offset0:104 offset1:108
    s_waitcnt lgkmcnt(2)
    v_mfma_f32_16x16x32_bf16 v[16:19], v[28:31], v[44:47], v[16:19]
    s_waitcnt lgkmcnt(1)
    v_mfma_f32_16x16x32_bf16 v[16:19], v[20:23], v[48:51], v[16:19]
    s_waitcnt lgkmcnt(0)
    v_mfma_f32_16x16x32_bf16 v[16:19], v[24:27], v[52:55], v[16:19]
    s_nop 7
    v_mov_b32 v27, -2
    v_mov_b32_dpp v25, v16 quad_perm:[1,0,3,2] row_mask:0xf bank_mask:0xf
    s_mul_i32 s70, s3, 32
    s_add_u32 s70, s70, 2752
    v_cvt_pk_bf16_f32 v25, v16, v25
    v_lshlrev_b32 v26, 1, v0
    v_add_u32 v26, s70, v26
    v_min_u32 v25, v25, v27
    s_mov_b64 exec, 0x5555
    ds_write_b32 v26, v25
    s_mov_b64 exec, -1
    v_lshlrev_b32 v26, 2, v0
    s_waitcnt lgkmcnt(0)
    s_barrier
    s_cmp_eq_u32 s3, 0
    s_cbranch_scc0 Lpw_63
    ds_read_b32 v25, v26 offset:2752
    s_mov_b32 exec_hi, 0
    s_waitcnt lgkmcnt(0)
    global_store_dword v26, v25, s[78:79] sc1
    s_mov_b64 exec, -1
Lpw_63:
    s_setpc_b64 s[88:89]
L_issue:
    s_mov_b32 m0, s40
    s_add_u32 s40, s40, 4096
    s_cmp_eq_u32 s40, s42
    s_cselect_b32 s40, s41, s40
    s_mov_b32 s90, s43
    s_cmp_eq_u32 s16, 0
    s_cbranch_scc1 L_is_k
    s_and_b32 s91, s43, 1
    s_lshl_b32 s90, s43, 1
    s_sub_u32 s90, s90, s91
    s_add_u32 s90, s90, s54
    s_bitcmp1_b32 s54, 31
    s_cbranch_scc1 L_is_vres
    s_add_u32 s91, s43, 28
    s_cmp_ge_u32 s43, 20
    s_cselect_b32 s90, s91, s90
    s_branch L_is_v2
L_is_vres:
    s_cmp_lt_u32 s43, 8
    s_cselect_b32 s90, s43, s90
L_is_v2:
    s_cmp_eq_u32 s14, 2
    s_cbranch_scc1 L_is_near
    s_branch L_is_own
L_is_k:
    s_cmp_eq_u32 s14, 1
    s_cbranch_scc0 L_is_own
    s_cmp_ge_u32 s43, 48
    s_cbranch_scc1 L_is_knear
    s_cmp_lt_u32 s43, 10
    s_cbranch_scc1 L_is_kown
    s_bitcmp1_b32 s43, 1
    s_cbranch_scc1 L_is_knear
L_is_kown:
    s_mov_b32 s36, s32
    s_mov_b32 s37, s33
L_is_own:
    s_lshl_b32 s91, s90, 11
    s_xor_b32 s91, s91, s17
    s_and_b32 s91, s91, 8192
    s_lshl_b32 s90, s90, 14
    s_add_u32 s90, s90, s101
    s_and_b32 s90, s90, 0xfffff
    s_add_u32 s15, s90, s91
    s_branch L_is_go
L_is_knear:
    s_mov_b32 s36, s10
    s_mov_b32 s37, s11
L_is_near:
    s_lshl_b32 s90, s90, 14
    s_add_u32 s90, s90, s0
    s_and_b32 s15, s90, 0xfffff
L_is_go:
    s_add_u32 s93, s93, 1
    s_and_b32 s93, s93, 1
    s_cmp_lt_u32 s93, s99
    s_cbranch_scc1 L_is_alloc
    buffer_load_dwordx4 v1, s[36:39], s15 offen offset:0 nt lds
    buffer_load_dwordx4 v2, s[36:39], s15 offen offset:1024 nt lds
    buffer_load_dwordx4 v3, s[36:39], s15 offen offset:2048 nt lds
    buffer_load_dwordx4 v4, s[36:39], s15 offen offset:3072 nt lds
    s_branch L_is_done
L_is_alloc:
    buffer_load_dwordx4 v1, s[36:39], s15 offen offset:0 lds
    buffer_load_dwordx4 v2, s[36:39], s15 offen offset:1024 lds
    buffer_load_dwordx4 v3, s[36:39], s15 offen offset:2048 lds
    buffer_load_dwordx4 v4, s[36:39], s15 offen offset:3072 lds
L_is_done:
    s_add_u32 s43, s43, 1
    s_cmp_lg_u32 s43, s44
    s_cbranch_scc0 L_is_next
    s_setpc_b64 s[66:67]
L_is_next:
    s_add_u32 s45, s45, 1
    s_mov_b32 s43, s81
    s_mov_b32 s99, s81
    s_mov_b32 s14, s81
    s_cmp_eq_u32 s45, 5
    s_cbranch_scc1 L_is_end
    s_bitcmp1_b32 s45, 0
    s_cbranch_scc0 L_is_v
    s_mov_b32 s16, s81
    s_add_u32 s44, s81, 64
    s_mov_b32 s36, s32
    s_mov_b32 s37, s33
    s_cmp_eq_u32 s45, 1
    s_cselect_b32 s99, 1, 0
    s_cselect_b32 s14, 0, 1
    s_add_u32 s99, s99, s81
    s_add_u32 s14, s14, s81
    v_lshrrev_b32 v2, 5, v0
    v_and_b32 v1, 31, v0
    v_xor_b32 v1, v1, v2
    v_lshlrev_b32 v1, 4, v1
    v_lshl_add_u32 v1, v2, 9, v1
    v_add_u32 v1, 3072, v1
    v_xor_b32 v2, 32, v1
    v_xor_b32 v3, 64, v1
    v_xor_b32 v4, 96, v1
    s_setpc_b64 s[66:67]
L_is_v:
    s_add_u32 s16, s81, 1
    s_add_u32 s44, s81, 36
    s_add_u32 s54, s81, 10
    s_cmp_eq_u32 s45, 2
    s_cselect_b32 s99, 1, 0
    s_cselect_b32 s14, 0, 2
    s_cselect_b32 s36, s34, s12
    s_cselect_b32 s37, s35, s13
    s_add_u32 s99, s99, s81
    s_add_u32 s14, s14, s81
    v_bfe_u32 v1, v0, 1, 3
    v_lshlrev_b32 v1, 9, v1
    v_lshrrev_b32 v2, 4, v0
    v_lshl_add_u32 v1, v2, 5, v1
    v_and_b32 v2, 1, v0
    v_lshl_add_u32 v1, v2, 4, v1
    v_add_u32 v1, 3072, v1
    v_subrev_u32 v2, 896, v1
    v_subrev_u32 v3, 1792, v1
    v_subrev_u32 v4, 2688, v1
    s_setpc_b64 s[66:67]
L_is_end:
    s_mov_b32 s38, 0
    s_mov_b32 s16, s81
    s_sub_u32 s44, s81, 1
    s_setpc_b64 s[66:67]
L_endcode:
    s_endpgm
.section .rodata,"a"
.p2align 6
.amdhsa_kernel interleave_layers__mha_block_cached__glu_gated_swiglu__decode_kernel
  .amdhsa_next_free_vgpr 512
  .amdhsa_next_free_sgpr 102
  .amdhsa_accum_offset 256
  .amdhsa_group_segment_fixed_size 0
  .amdhsa_kernarg_size 96
  .amdhsa_user_sgpr_count 2
  .amdhsa_user_sgpr_kernarg_segment_ptr 1
  .amdhsa_system_sgpr_workgroup_id_x 1
  .amdhsa_float_denorm_mode_32 3
.end_amdhsa_kernel
```
